```python
import torch

def _softmax(x, axis=-1):
    return torch.softmax(x, dim=axis)
def _gelu(x):
    return torch.nn.functional.gelu(x, approximate="tanh")
def _silu(x):
    return torch.nn.functional.silu(x)
def _sigmoid(x):
    return torch.sigmoid(x)
def _layernorm(x, axis=-1, eps=1e-5):
    m = x.mean(dim=axis, keepdim=True)
    v = x.var(dim=axis, keepdim=True, unbiased=False)
    return (x - m) / torch.sqrt(v + eps)
def _scatter_add(tgt, idx, src, axis=0):
    return tgt.clone().index_add_(axis, idx, src)
def _segment_sum(src, seg, n):
    out = torch.zeros((n,) + src.shape[1:], dtype=src.dtype)
    return out.index_add_(0, seg, src)
def _pad(x, pw):
    flat = tuple(v for pair in reversed(pw) for v in pair)
    return torch.nn.functional.pad(x, flat)

kernel_name = 'parallel_sum__linear_attn_block__dense_activation_mish__prompt'

def setup_inputs():

    _w = (lambda a: (lambda t: t.to(torch.bfloat16) if t.is_floating_point() else t)(torch.as_tensor(a)))
    def _A_setup():
        B, S, D = 1, 2048, 512
        return {
            "x": _w((lambda *s: torch.randn(*s, dtype=torch.bfloat16) * 0.05)(B, S, D)),
            "wqkv": _w((lambda *s: torch.randn(*s, dtype=torch.bfloat16) * 0.1)(D, 3 * D)),
            "wo": _w((lambda *s: torch.randn(*s, dtype=torch.bfloat16) * 0.05)(D, D)),
        }
    _A_in = _A_setup()

    def _B_setup():
        B, S, D, F = 1, 2048, 512, 1792
        return {
            "x": _w((lambda *s: torch.randn(*s, dtype=torch.bfloat16) * 0.05)(B, S, D)),
            "w1": _w((lambda *s: torch.randn(*s, dtype=torch.bfloat16) * 0.8)(D, F) * (D ** -0.5)),
            "b1": _w((lambda *s: torch.randn(*s, dtype=torch.bfloat16) * 0.4)(F)),
            "w2": _w((lambda *s: torch.randn(*s, dtype=torch.bfloat16) * 0.1)(F, D) * (F ** -0.5)),
        }
    _B_in = _B_setup()

    return {
        "A_x": _A_in["x"],
        "A_wqkv": _A_in["wqkv"],
        "A_wo": _A_in["wo"],
        "B_x": _B_in["x"],
        "B_w1": _B_in["w1"],
        "B_b1": _B_in["b1"],
        "B_w2": _B_in["w2"],
    }

def reference(A_x, A_wqkv, A_wo, B_x, B_w1, B_b1, B_w2):
    def _A_ref(x, wqkv, wo):
        B, S, D = x.shape
        H = 32; Dh = D // H
        qkv = (lambda x, *d: x.permute(*d))((x @ wqkv).reshape(B, S, 3, H, Dh), 2, 0, 3, 1, 4)
        q, k, v = qkv[0], qkv[1], qkv[2]
        phi = lambda t: torch.where(t > 0, t + 1, torch.exp(t)) + 1e-6
        pq, pk = phi(q), phi(k)
        kv = torch.einsum("bhsd,bhse->bhde", pk, v)
        z = torch.einsum("bhsd->bhd", pk)
        num = torch.einsum("bhqd,bhde->bhqe", pq, kv)
        den = torch.einsum("bhqd,bhd->bhq", pq, z)[..., None] + 1e-6
        o = num / den
        return (lambda x, *d: x.permute(*d))(o, 0, 2, 1, 3).reshape(B, S, D) @ wo

    def _B_ref(x, w1, b1, w2):
        h = torch.einsum("bsd,df->bsf", x, w1) + b1
        sp = torch.log1p(torch.exp(-torch.abs(h))) + torch.where(h > 0, h, torch.zeros_like(h))
        act = h * torch.tanh(sp)
        return torch.einsum("bsf,fd->bsd", act, w2)

    x = A_x
    xn = _layernorm(x, axis=-1)
    return x + _A_ref(xn, A_wqkv, A_wo) + _B_ref(xn, B_w1, B_b1, B_w2)
```

```asm
; @launch grid=(256,1,1) block=(512,1,1) lds=163840
.amdgcn_target "amdgcn-amd-amdhsa--gfx950"
.text
.globl parallel_sum__linear_attn_block__dense_activation_mish__prompt_kernel
.p2align 8
.type parallel_sum__linear_attn_block__dense_activation_mish__prompt_kernel,@function
parallel_sum__linear_attn_block__dense_activation_mish__prompt_kernel:
    s_load_dwordx16 s[16:31], s[0:1], 0
    s_load_dwordx2 s[34:35], s[0:1], 72
    s_cmp_ge_u32 s2, 256
    s_cbranch_scc1 L_end
    v_readfirstlane_b32 s3, v0
    v_and_b32 v0, 63, v0
    s_lshr_b32 s10, s2, 3
    s_bfe_u32 s71, s2, 0x10002
    s_lshl_b32 s4, s71, 3
    s_lshr_b32 s70, s2, 5
    s_add_u32 s4, s4, s70
    s_add_u32 s70, s70, s2
    s_and_b32 s70, s70, 3
    s_lshl_b32 s70, s70, 1
    s_add_u32 s7, s70, s71
    s_and_b32 s5, s2, 3
    s_lshl_b32 s5, s5, 1
    s_and_b32 s71, s10, 1
    s_add_u32 s5, s5, s71
    s_lshr_b32 s3, s3, 6
    s_bfe_u32 s6, s2, 0x10004
    s_cmp_lt_u32 s3, 4
    s_cbranch_scc1 L_helper
    s_sub_u32 s3, s3, 4
    s_setprio 1
    s_and_b32 s11, s3, 1
    s_lshr_b32 s12, s3, 1
    s_getpc_b64 s[44:45]
L_pc_1:
    s_lshl_b32 s70, s10, 2
    s_add_u32 s70, s70, s3
    s_lshl_b32 s70, s70, 8
    s_min_u32 s70, s70, L_code_end-L_pc_1-196
    s_add_u32 s44, s44, s70
    s_addc_u32 s45, s45, 0
    v_lshlrev_b32_e64 v225, 4, v0
    v_and_b32 v228, 15, v0
    s_lshl_b32 s70, s6, 3
    s_add_u32 s70, s70, s5
    s_lshl_b32 s70, s70, 2
    s_add_u32 s70, s70, s3
    s_lshl_b32 s71, s4, 6
    s_add_u32 s71, s70, s71
    s_lshl_b32 s71, s71, 11
    s_mov_b32 s38, 2097152
    s_mov_b32 s39, 0x20000
    s_mov_b32 s62, 3584
    s_mov_b32 s63, 0x20000
    s_lshr_b32 s70, s5, 1
    s_mul_i32 s70, s70, 448
    s_and_b32 s72, s5, 1
    s_lshl_b32 s65, s72, 8
    s_add_u32 s65, s65, s70
    s_lshl_b32 s73, s12, 5
    s_add_u32 s65, s65, s73
    s_lshl_b32 s78, s72, 5
    s_add_u32 s78, s78, s70
    s_add_u32 s78, s78, 192
    v_bfe_u32 v5, v0, 4, 1
    v_xor_b32 v5, s11, v5
    v_lshl_add_u32 v2, v5, 4, v228
    v_lshrrev_b32 v3, 5, v0
    v_lshl_add_u32 v4, v3, 6, v2
    v_add_lshl_u32 v4, v4, s65, 1
    s_sub_u32 s70, s78, s65
    s_nop 0
    s_sub_u32 s70, s70, 128
    v_mul_lo_u32 v6, v3, s70
    v_add3_u32 v6, v6, v2, s65
    v_add_u32 v6, 128, v6
    v_lshlrev_b32 v6, 1, v6
    s_waitcnt lgkmcnt(0)
    s_mov_b32 s36, s16
    s_mov_b32 s37, s17
    buffer_load_dwordx4 v[128:131], v225, s[36:39], s71 offen offset:0
    buffer_load_dwordx4 v[132:135], v225, s[36:39], s71 offen offset:1024
    s_load_dwordx2 s[68:69], s[34:35], 0
    s_mov_b32 s60, s26
    s_mov_b32 s61, s27
    buffer_load_ushort v8, v4, s[60:63], 0 offen
    buffer_load_ushort v9, v6, s[60:63], 0 offen
    s_load_dword s46, s[44:45], 0
    s_load_dword s46, s[44:45], 64
    s_load_dword s46, s[44:45], 128
    s_load_dword s46, s[44:45], 192
    s_branch L_compute
L_helper:
    v_lshrrev_b32 v40, 3, v0
    v_and_b32 v41, 7, v0
    v_lshrrev_b32 v42, 4, v0
    v_xor_b32 v43, v41, v42
    v_lshlrev_b32 v43, 4, v43
    v_lshl_add_u32 v2, v40, 10, v43
    v_xor_b32_e64 v3, 64, v2
    v_add_u32 v3, 7168, v3
    v_add_u32 v4, 14336, v2
    v_add_u32 v5, 14336, v3
    s_lshl_b32 s13, s3, 12
    s_lshl_b32 s11, s4, 17
    s_lshl_b32 s70, s3, 15
    s_add_u32 s11, s11, s70
    s_lshl_b32 s71, s7, 7
    s_add_u32 s71, s71, s11
    s_mov_b32 m0, s13
    s_nop 0
    s_mov_b32 s38, 2097152
    s_mov_b32 s39, 0x20000
    s_mov_b32 s43, 0x20000
    s_lshr_b32 s70, s5, 1
    s_mul_i32 s70, s70, 896
    s_and_b32 s72, s5, 1
    s_lshl_b32 s73, s72, 9
    s_add_u32 s70, s70, s73
    s_mul_i32 s76, s72, -448
    s_add_u32 s76, s76, 384
    s_lshl_b32 s72, s5, 7
    s_lshl_b32 s73, s6, 9
    s_add_u32 s73, s73, 3072
    s_lshl_b32 s77, s73, 6
    s_lshl_b32 s42, s73, 9
    s_mul_i32 s12, s73, s3
    s_lshl_b32 s12, s12, 4
    v_and_b32 v43, 1, v42
    v_lshlrev_b32 v43, 1, v43
    v_xor_b32 v43, v41, v43
    v_lshlrev_b32 v43, 4, v43
    v_mad_u32_u24 v6, v40, s73, v43
    s_lshl_b32 s74, s73, 3
    s_sub_u32 s74, s74, 1024
    v_xor_b32 v7, 64, v6
    v_add_u32 v7, s74, v7
    v_lshrrev_b32 v44, 2, v0
    v_and_b32 v45, 3, v0
    v_and_b32 v46, 2, v42
    v_xor_b32 v45, v45, v46
    v_lshlrev_b32 v45, 4, v45
    v_mad_u32_u24 v8, v44, s73, v45
    s_lshl_b32 s14, s3, 11
    s_lshl_b32 s15, s3, 10
    s_add_u32 s15, s15, 40960
    s_cmp_lg_u32 s6, 0
    s_cselect_b32 s70, s70, s72
    s_add_u32 s12, s12, s70
    s_mov_b32 s78, 0
    s_mov_b32 s61, s7
    s_waitcnt lgkmcnt(0)
    s_mov_b32 s36, s16
    s_mov_b32 s37, s17
    buffer_load_dwordx4 v2, s[36:39], s71 offen offset:0 lds
    buffer_load_dwordx4 v3, s[36:39], s71 offen offset:1024 lds
    buffer_load_dwordx4 v4, s[36:39], s71 offen offset:2048 lds
    buffer_load_dwordx4 v5, s[36:39], s71 offen offset:3072 lds
    s_cmp_lg_u32 s6, 0
    s_cselect_b32 s40, s24, s18
    s_cselect_b32 s41, s25, s19
    s_movk_i32 s23, 1024
    s_cselect_b32 s23, 128, s23
    s_add_u32 s74, s78, s14
    s_mul_i32 s72, s7, s77
    s_add_u32 m0, s74, 16384
    s_add_u32 s72, s72, s12
    s_nop 0
    buffer_load_dwordx4 v6, s[40:43], s72 offen offset:0 lds
    buffer_load_dwordx4 v7, s[40:43], s72 offen offset:1024 lds
    s_add_u32 m0, s74, 24576
    s_add_u32 s73, s72, s23
    s_nop 0
    buffer_load_dwordx4 v6, s[40:43], s73 offen offset:0 lds
    buffer_load_dwordx4 v7, s[40:43], s73 offen offset:1024 lds
    s_add_u32 m0, s74, 32768
    s_add_u32 s73, s73, s23
    buffer_load_dwordx4 v6, s[40:43], s73 offen offset:0 lds
    buffer_load_dwordx4 v7, s[40:43], s73 offen offset:1024 lds
    s_cmp_eq_u32 s6, 0
    s_cbranch_scc1 L_nostrip_2
    s_add_u32 m0, s78, s15
    s_add_u32 s73, s72, s76
    buffer_load_dwordx4 v8, s[40:43], s73 offen lds
L_nostrip_2:
    s_add_u32 s7, s7, 1
    s_and_b32 s7, s7, 7
    s_add_u32 s78, s78, 45056
    s_cmp_eq_u32 s78, 135168
    s_cselect_b32 s78, 0, s78
    s_and_b32 s8, s2, 7
    s_lshl_b32 s8, s8, 2
    s_lshr_b32 s70, s2, 6
    s_add_u32 s8, s8, s70
    s_mov_b32 s71, 1696023043
    s_cmp_eq_u32 s70, 1
    s_cselect_b32 s71, 1699156003, s71
    s_cmp_eq_u32 s70, 2
    s_cselect_b32 s71, 1114050643, s71
    s_cmp_eq_u32 s70, 3
    s_cselect_b32 s71, 1699160323, s71
    s_and_b32 s9, s10, 7
    s_lshl_b32 s9, s9, 2
    s_lshr_b32 s9, s71, s9
    s_and_b32 s9, s9, 7
    s_lshl_b32 s64, s6, 11
    s_add_u32 s64, s64, 149504
    s_mov_b32 s44, s28
    s_mov_b32 s45, s29
    s_mov_b32 s46, 1835008
    s_mov_b32 s47, 0x20000
    s_mov_b32 s48, s20
    s_mov_b32 s49, s21
    s_mov_b32 s50, 524288
    s_mov_b32 s51, 0x20000
    s_mov_b32 s52, s34
    s_mov_b32 s53, s35
    s_mov_b32 s54, 11534336
    s_mov_b32 s55, 0x20000
    v_lshlrev_b32 v43, 1, v42
    v_xor_b32 v43, v41, v43
    v_lshlrev_b32 v43, 4, v43
    v_lshl_add_u32 v9, v40, 10, v43
    v_add_u32 v10, 7168, v9
    v_lshlrev_b32 v11, 4, v0
    s_and_b32 s70, s8, 1
    s_xor_b32 s70, s70, s3
    s_lshl_b32 s60, s70, 14
    s_lshl_b32 s70, s9, 7
    s_add_u32 s60, s60, s70
    s_lshl_b32 s70, s3, 8
    v_lshl_add_u32 v12, v0, 2, s70
    v_add_u32 v13, 148480, v12
    s_lshl_b32 s70, s6, 3
    s_add_u32 s70, s70, s5
    s_lshl_b32 s62, s70, 13
    s_add_u32 s62, s62, 196608
    s_lshl_b32 s63, s4, 11
    s_add_u32 s63, s63, 4096
    s_lshl_b32 s70, s70, 7
    s_add_u32 s22, s63, s70
    s_lshl_b32 s70, s3, 9
    s_add_u32 s63, s63, s70
    s_cmp_eq_u32 s3, 0
    s_nop 0
    s_cselect_b32 s22, s22, 0x7ff00000
    v_and_b32 v15, 0x1f0, v11
    v_and_b32 v46, 0x70, v11
    v_add_u32 v47, s64, v46
    v_and_b32 v44, 31, v0
    s_lshl_b32 s70, s3, 7
    s_add_u32 s70, s70, 147456
    v_lshl_add_u32 v16, v44, 2, s70
    v_mov_b32 v17, s64
    v_and_b32 v45, 3, v0
    v_lshlrev_b32 v45, 3, v45
    s_lshl_b32 s70, s10, 2
    s_add_u32 s70, s70, s3
    s_mul_i32 s71, s70, 14336
    s_lshl_b32 s70, s70, 12
    s_add_u32 s56, s28, s71
    s_addc_u32 s57, s29, 0
    s_add_u32 s58, s20, s70
    s_addc_u32 s59, s21, 0
    s_lshl_b32 s71, s7, 7
    s_add_u32 m0, s78, s13
    s_add_u32 s71, s71, s11
    buffer_load_dwordx4 v2, s[36:39], s71 offen offset:0 lds
    buffer_load_dwordx4 v3, s[36:39], s71 offen offset:1024 lds
    buffer_load_dwordx4 v4, s[36:39], s71 offen offset:2048 lds
    buffer_load_dwordx4 v5, s[36:39], s71 offen offset:3072 lds
    s_add_u32 s74, s78, s14
    s_mul_i32 s72, s7, s77
    s_add_u32 m0, s74, 16384
    s_add_u32 s72, s72, s12
    s_nop 0
    buffer_load_dwordx4 v6, s[40:43], s72 offen offset:0 lds
    buffer_load_dwordx4 v7, s[40:43], s72 offen offset:1024 lds
    s_add_u32 m0, s74, 24576
    s_add_u32 s73, s72, s23
    buffer_load_dwordx4 v6, s[40:43], s73 offen offset:0 lds
    buffer_load_dwordx4 v7, s[40:43], s73 offen offset:1024 lds
    s_waitcnt vmcnt(8)
    s_barrier
    s_add_u32 m0, s74, 32768
    s_add_u32 s73, s73, s23
    buffer_load_dwordx4 v6, s[40:43], s73 offen offset:0 lds
    buffer_load_dwordx4 v7, s[40:43], s73 offen offset:1024 lds
    s_cmp_eq_u32 s6, 0
    s_cbranch_scc1 L_nostrip_3
    s_add_u32 m0, s78, s15
    s_add_u32 s73, s72, s76
    buffer_load_dwordx4 v8, s[40:43], s73 offen lds
L_nostrip_3:
    s_add_u32 s7, s7, 1
    s_and_b32 s7, s7, 7
    s_add_u32 s78, s78, 45056
    s_cmp_eq_u32 s78, 135168
    s_cselect_b32 s78, 0, s78
    ds_read_b64 v[18:19], v17
    s_lshl_b32 s71, s7, 7
    s_add_u32 m0, s78, s13
    s_add_u32 s71, s71, s11
    buffer_load_dwordx4 v2, s[36:39], s71 offen offset:0 lds
    buffer_load_dwordx4 v3, s[36:39], s71 offen offset:1024 lds
    buffer_load_dwordx4 v4, s[36:39], s71 offen offset:2048 lds
    buffer_load_dwordx4 v5, s[36:39], s71 offen offset:3072 lds
    s_add_u32 s74, s78, s14
    s_mul_i32 s72, s7, s77
    s_add_u32 m0, s74, 16384
    s_add_u32 s72, s72, s12
    s_nop 0
    buffer_load_dwordx4 v6, s[40:43], s72 offen offset:0 lds
    buffer_load_dwordx4 v7, s[40:43], s72 offen offset:1024 lds
    s_add_u32 m0, s74, 24576
    s_add_u32 s73, s72, s23
    s_nop 0
    buffer_load_dwordx4 v6, s[40:43], s73 offen offset:0 lds
    buffer_load_dwordx4 v7, s[40:43], s73 offen offset:1024 lds
    s_add_u32 m0, s74, 32768
    s_add_u32 s73, s73, s23
    buffer_load_dwordx4 v6, s[40:43], s73 offen offset:0 lds
    buffer_load_dwordx4 v7, s[40:43], s73 offen offset:1024 lds
    s_cmp_eq_u32 s6, 0
    s_cbranch_scc1 L_nostrip_4
    s_add_u32 m0, s78, s15
    s_add_u32 s73, s72, s76
    buffer_load_dwordx4 v8, s[40:43], s73 offen lds
L_nostrip_4:
    s_add_u32 s7, s7, 1
    s_and_b32 s7, s7, 7
    s_add_u32 s78, s78, 45056
    s_cmp_eq_u32 s78, 135168
    s_cselect_b32 s78, 0, s78
    s_waitcnt lgkmcnt(0)
    v_bfe_u32 v14, v18, v45, 8
    v_bfi_b32 v14, 1, v18, v14
    s_waitcnt vmcnt(10)
    s_barrier
    ds_read_b32 v20, v13
    ds_read_b128 v[24:27], v47 offset:128
    s_lshl_b32 s71, s7, 7
    s_add_u32 m0, s78, s13
    s_add_u32 s71, s71, s11
    buffer_load_dwordx4 v2, s[36:39], s71 offen offset:0 lds
    buffer_load_dwordx4 v3, s[36:39], s71 offen offset:1024 lds
    buffer_load_dwordx4 v4, s[36:39], s71 offen offset:2048 lds
    buffer_load_dwordx4 v5, s[36:39], s71 offen offset:3072 lds
    s_add_u32 s74, s78, s14
    s_mul_i32 s72, s7, s77
    s_add_u32 m0, s74, 16384
    s_add_u32 s72, s72, s12
    s_nop 0
    buffer_load_dwordx4 v6, s[40:43], s72 offen offset:0 lds
    buffer_load_dwordx4 v7, s[40:43], s72 offen offset:1024 lds
    s_add_u32 m0, s74, 24576
    s_add_u32 s73, s72, s23
    s_nop 0
    buffer_load_dwordx4 v6, s[40:43], s73 offen offset:0 lds
    buffer_load_dwordx4 v7, s[40:43], s73 offen offset:1024 lds
    s_add_u32 m0, s74, 32768
    s_add_u32 s73, s73, s23
    buffer_load_dwordx4 v6, s[40:43], s73 offen offset:0 lds
    buffer_load_dwordx4 v7, s[40:43], s73 offen offset:1024 lds
    s_cmp_eq_u32 s6, 0
    s_cbranch_scc1 L_nostrip_5
    s_add_u32 m0, s78, s15
    s_add_u32 s73, s72, s76
    buffer_load_dwordx4 v8, s[40:43], s73 offen lds
L_nostrip_5:
    s_add_u32 s7, s7, 1
    s_and_b32 s7, s7, 7
    s_add_u32 s78, s78, 45056
    s_cmp_eq_u32 s78, 135168
    s_cselect_b32 s78, 0, s78
    s_lshl_b32 s70, s61, 10
    s_add_u32 s70, s70, s62
    s_movk_i32 s71, 0xff
    s_waitcnt lgkmcnt(0)
    v_add_u32 v20, 0x80, v20
    v_bfi_b32 v20, s71, v14, v20
    buffer_store_dword v20, v12, s[52:55], s70 offen sc1
    s_mov_b64 exec, 0xff
    buffer_store_dwordx4 v[24:27], v46, s[52:55], s22 offen sc1
    s_mov_b64 exec, -1
    s_waitcnt vmcnt(12)
    s_barrier
    s_lshl_b32 s71, s7, 7
    s_add_u32 m0, s78, s13
    s_add_u32 s71, s71, s11
    buffer_load_dwordx4 v2, s[36:39], s71 offen offset:0 lds
    buffer_load_dwordx4 v3, s[36:39], s71 offen offset:1024 lds
    buffer_load_dwordx4 v4, s[36:39], s71 offen offset:2048 lds
    buffer_load_dwordx4 v5, s[36:39], s71 offen offset:3072 lds
    s_add_u32 s74, s78, s14
    s_mul_i32 s72, s7, s77
    s_add_u32 m0, s74, 16384
    s_add_u32 s72, s72, s12
    s_nop 0
    buffer_load_dwordx4 v6, s[40:43], s72 offen offset:0 lds
    buffer_load_dwordx4 v7, s[40:43], s72 offen offset:1024 lds
    s_add_u32 m0, s74, 24576
    s_add_u32 s73, s72, s23
    s_nop 0
    buffer_load_dwordx4 v6, s[40:43], s73 offen offset:0 lds
    buffer_load_dwordx4 v7, s[40:43], s73 offen offset:1024 lds
    s_add_u32 m0, s74, 32768
    s_add_u32 s73, s73, s23
    buffer_load_dwordx4 v6, s[40:43], s73 offen offset:0 lds
    buffer_load_dwordx4 v7, s[40:43], s73 offen offset:1024 lds
    s_cmp_eq_u32 s6, 0
    s_cbranch_scc1 L_nostrip_6
    s_add_u32 m0, s78, s15
    s_add_u32 s73, s72, s76
    buffer_load_dwordx4 v8, s[40:43], s73 offen lds
L_nostrip_6:
    s_add_u32 s7, s7, 1
    s_and_b32 s7, s7, 7
    s_add_u32 s78, s78, 45056
    s_cmp_eq_u32 s78, 135168
    s_cselect_b32 s78, 0, s78
    s_xor_b32 s70, s2, 0
    s_lshl_b32 s70, s70, 2
    s_add_u32 s70, s70, s3
    s_mul_i32 s71, s70, 1792
    s_lshl_b32 s70, s70, 9
    v_min_u32 v55, 13, v0
    v_lshlrev_b32 v55, 7, v55
    buffer_load_dword v56, v55, s[44:47], s71 offen
    v_min_u32 v55, 0x180, v55
    buffer_load_dword v56, v55, s[48:51], s70 offen
    s_waitcnt vmcnt(14)
    s_barrier
    s_lshl_b32 s71, s7, 7
    s_add_u32 m0, s78, s13
    s_add_u32 s71, s71, s11
    s_nop 0
    buffer_load_dwordx4 v2, s[36:39], s71 offen offset:0 lds
    buffer_load_dwordx4 v3, s[36:39], s71 offen offset:1024 lds
    buffer_load_dwordx4 v4, s[36:39], s71 offen offset:2048 lds
    buffer_load_dwordx4 v5, s[36:39], s71 offen offset:3072 lds
    s_add_u32 s74, s78, s14
    s_mul_i32 s72, s7, s77
    s_add_u32 m0, s74, 16384
    s_add_u32 s72, s72, s12
    s_nop 0
    buffer_load_dwordx4 v6, s[40:43], s72 offen offset:0 lds
    buffer_load_dwordx4 v7, s[40:43], s72 offen offset:1024 lds
    s_add_u32 m0, s74, 24576
    s_add_u32 s73, s72, s23
    s_nop 0
    buffer_load_dwordx4 v6, s[40:43], s73 offen offset:0 lds
    buffer_load_dwordx4 v7, s[40:43], s73 offen offset:1024 lds
    s_add_u32 m0, s74, 32768
    s_add_u32 s73, s73, s23
    buffer_load_dwordx4 v6, s[40:43], s73 offen offset:0 lds
    buffer_load_dwordx4 v7, s[40:43], s73 offen offset:1024 lds
    s_cmp_eq_u32 s6, 0
    s_cbranch_scc1 L_nostrip_7
    s_add_u32 m0, s78, s15
    s_add_u32 s73, s72, s76
    buffer_load_dwordx4 v8, s[40:43], s73 offen lds
L_nostrip_7:
    s_add_u32 s7, s7, 1
    s_and_b32 s7, s7, 7
    s_add_u32 s78, s78, 45056
    s_cmp_eq_u32 s78, 135168
    s_cselect_b32 s78, 0, s78
    s_load_dword s65, s[56:57], 384
    s_load_dword s65, s[56:57], 448
    s_load_dword s65, s[56:57], 1408
    s_load_dword s65, s[56:57], 1472
    s_load_dword s65, s[56:57], 2432
    s_load_dword s65, s[56:57], 2496
    s_load_dword s65, s[56:57], 3456
    s_load_dword s65, s[56:57], 3520
    s_load_dword s65, s[56:57], 4480
    s_load_dword s65, s[56:57], 4544
    s_load_dword s65, s[56:57], 5504
    s_load_dword s65, s[56:57], 5568
    s_waitcnt vmcnt(12)
    s_barrier
    s_lshl_b32 s71, s7, 7
    s_add_u32 m0, s78, s13
    s_add_u32 s71, s71, s11
    s_nop 0
    buffer_load_dwordx4 v2, s[36:39], s71 offen offset:0 lds
    buffer_load_dwordx4 v3, s[36:39], s71 offen offset:1024 lds
    buffer_load_dwordx4 v4, s[36:39], s71 offen offset:2048 lds
    buffer_load_dwordx4 v5, s[36:39], s71 offen offset:3072 lds
    s_add_u32 s74, s78, s14
    s_mul_i32 s72, s7, s77
    s_add_u32 m0, s74, 16384
    s_add_u32 s72, s72, s12
    s_nop 0
    buffer_load_dwordx4 v6, s[40:43], s72 offen offset:0 lds
    buffer_load_dwordx4 v7, s[40:43], s72 offen offset:1024 lds
    s_add_u32 m0, s74, 24576
    s_add_u32 s73, s72, s23
    s_nop 0
    buffer_load_dwordx4 v6, s[40:43], s73 offen offset:0 lds
    buffer_load_dwordx4 v7, s[40:43], s73 offen offset:1024 lds
    s_add_u32 m0, s74, 32768
    s_add_u32 s73, s73, s23
    buffer_load_dwordx4 v6, s[40:43], s73 offen offset:0 lds
    buffer_load_dwordx4 v7, s[40:43], s73 offen offset:1024 lds
    s_cmp_eq_u32 s6, 0
    s_cbranch_scc1 L_nostrip_8
    s_add_u32 m0, s78, s15
    s_add_u32 s73, s72, s76
    buffer_load_dwordx4 v8, s[40:43], s73 offen lds
L_nostrip_8:
    s_add_u32 s7, s7, 1
    s_and_b32 s7, s7, 7
    s_add_u32 s78, s78, 45056
    s_cmp_eq_u32 s78, 135168
    s_cselect_b32 s78, 0, s78
    s_load_dword s65, s[56:57], 6528
    s_load_dword s65, s[56:57], 6592
    s_load_dword s65, s[56:57], 7552
    s_load_dword s65, s[56:57], 7616
    s_load_dword s65, s[56:57], 8576
    s_load_dword s65, s[56:57], 8640
    s_load_dword s65, s[56:57], 9600
    s_load_dword s65, s[56:57], 9664
    s_load_dword s65, s[56:57], 10624
    s_load_dword s65, s[56:57], 10688
    s_load_dword s65, s[56:57], 11648
    s_load_dword s65, s[56:57], 11712
    s_waitcnt vmcnt(10)
    s_barrier
    s_lshl_b32 s71, s7, 7
    s_add_u32 m0, s78, s13
    s_add_u32 s71, s71, s11
    s_nop 0
    buffer_load_dwordx4 v2, s[36:39], s71 offen offset:0 lds
    buffer_load_dwordx4 v3, s[36:39], s71 offen offset:1024 lds
    buffer_load_dwordx4 v4, s[36:39], s71 offen offset:2048 lds
    buffer_load_dwordx4 v5, s[36:39], s71 offen offset:3072 lds
    s_add_u32 s74, s78, s14
    s_mul_i32 s72, s7, s77
    s_add_u32 m0, s74, 16384
    s_add_u32 s72, s72, s12
    s_nop 0
    buffer_load_dwordx4 v6, s[40:43], s72 offen offset:0 lds
    buffer_load_dwordx4 v7, s[40:43], s72 offen offset:1024 lds
    s_add_u32 m0, s74, 24576
    s_add_u32 s73, s72, s23
    s_nop 0
    buffer_load_dwordx4 v6, s[40:43], s73 offen offset:0 lds
    buffer_load_dwordx4 v7, s[40:43], s73 offen offset:1024 lds
    s_add_u32 m0, s74, 32768
    s_add_u32 s73, s73, s23
    buffer_load_dwordx4 v6, s[40:43], s73 offen offset:0 lds
    buffer_load_dwordx4 v7, s[40:43], s73 offen offset:1024 lds
    s_cmp_eq_u32 s6, 0
    s_cbranch_scc1 L_nostrip_9
    s_add_u32 m0, s78, s15
    s_add_u32 s73, s72, s76
    buffer_load_dwordx4 v8, s[40:43], s73 offen lds
L_nostrip_9:
    s_add_u32 s7, s7, 1
    s_and_b32 s7, s7, 7
    s_add_u32 s78, s78, 45056
    s_cmp_eq_u32 s78, 135168
    s_cselect_b32 s78, 0, s78
    s_load_dword s65, s[56:57], 12672
    s_load_dword s65, s[56:57], 12736
    s_load_dword s65, s[56:57], 13696
    s_load_dword s65, s[56:57], 13760
    s_load_dword s65, s[58:59], 384
    s_load_dword s65, s[58:59], 448
    s_load_dword s65, s[58:59], 1408
    s_load_dword s65, s[58:59], 1472
    s_load_dword s65, s[58:59], 2432
    s_load_dword s65, s[58:59], 2496
    s_load_dword s65, s[58:59], 3456
    s_load_dword s65, s[58:59], 3520
    s_waitcnt vmcnt(10)
    s_barrier
    s_add_u32 s75, s62, 4096
    buffer_load_dword v20, v12, s[52:55], s62 offen offset:0 sc1
    buffer_load_dword v21, v12, s[52:55], s62 offen offset:1024 sc1
    buffer_load_dword v22, v12, s[52:55], s62 offen offset:2048 sc1
    buffer_load_dword v23, v12, s[52:55], s62 offen offset:3072 sc1
    buffer_load_dword v24, v12, s[52:55], s75 offen offset:0 sc1
    buffer_load_dword v25, v12, s[52:55], s75 offen offset:1024 sc1
    buffer_load_dword v26, v12, s[52:55], s75 offen offset:2048 sc1
    buffer_load_dword v27, v12, s[52:55], s75 offen offset:3072 sc1
    buffer_load_dwordx4 v[28:31], v15, s[52:55], s63 offen sc1
    s_add_u32 m0, s14, 114688
    s_add_u32 s74, s60, 0
    s_nop 0
    buffer_load_dwordx4 v9, s[44:47], s74 offen offset:0 lds
    buffer_load_dwordx4 v10, s[44:47], s74 offen offset:1024 lds
    s_add_u32 m0, s14, 122880
    s_add_u32 s74, s60, 458752
    buffer_load_dwordx4 v9, s[44:47], s74 offen offset:0 lds
    buffer_load_dwordx4 v10, s[44:47], s74 offen offset:1024 lds
    s_add_u32 m0, s14, 131072
    s_add_u32 s74, s60, 917504
    buffer_load_dwordx4 v9, s[44:47], s74 offen offset:0 lds
    buffer_load_dwordx4 v10, s[44:47], s74 offen offset:1024 lds
    s_add_u32 m0, s14, 139264
    s_add_u32 s74, s60, 1376256
    buffer_load_dwordx4 v9, s[44:47], s74 offen offset:0 lds
    buffer_load_dwordx4 v10, s[44:47], s74 offen offset:1024 lds
    s_add_u32 m0, s14, 90112
    s_add_u32 s74, s60, 524288
    buffer_load_dwordx4 v9, s[44:47], s74 offen offset:0 lds
    buffer_load_dwordx4 v10, s[44:47], s74 offen offset:1024 lds
    s_add_u32 m0, s14, 98304
    s_add_u32 s74, s60, 983040
    buffer_load_dwordx4 v9, s[44:47], s74 offen offset:0 lds
    buffer_load_dwordx4 v10, s[44:47], s74 offen offset:1024 lds
    s_waitcnt vmcnt(21)
    s_barrier
    s_mov_b32 s79, 200000
    s_waitcnt vmcnt(12)
L_xchk_10:
    v_xor_b32_e64 v20, v14, v20
    v_xor_b32 v21, v14, v21
    v_xor_b32 v22, v14, v22
    v_xor_b32 v23, v14, v23
    v_xor_b32 v24, v14, v24
    v_xor_b32 v25, v14, v25
    v_xor_b32 v26, v14, v26
    v_xor_b32 v27, v14, v27
    v_or3_b32 v32, v20, v21, v22
    v_or3_b32 v32, v32, v23, v24
    v_or3_b32 v32, v32, v25, v26
    v_or_b32 v32, v32, v27
    v_and_b32 v32, 0xff, v32
    v_and_b32 v33, 1, v18
    v_xor_b32 v28, v33, v28
    v_xor_b32 v29, v33, v29
    v_or_b32 v33, v28, v29
    v_and_or_b32 v32, v33, 1, v32
    v_xor_b32 v30, v18, v30
    v_xor_b32 v31, v19, v31
    v_or3_b32 v32, v32, v30, v31
    v_cmp_ne_u32 vcc, 0, v32
    s_nop 0
    s_cmp_lg_u64 vcc, 0
    s_cbranch_scc1 L_xretry_11
L_xdone_12:
    ds_write_b32 v16, v28
    ds_write_b32 v16, v29 offset:512
    v_add_f32 v20, v20, v21
    v_add_f32 v22, v22, v23
    v_add_f32 v24, v24, v25
    v_add_f32 v26, v26, v27
    v_add_f32 v20, v20, v22
    v_add_f32 v24, v24, v26
    v_add_f32 v20, v20, v24
    ds_write_b32 v13, v20
    s_add_u32 m0, s14, 0
    s_nop 0
    s_add_u32 s74, s60, 262144
    buffer_load_dwordx4 v9, s[44:47], s74 offen offset:0 lds
    buffer_load_dwordx4 v10, s[44:47], s74 offen offset:1024 lds
    s_add_u32 m0, s14, 8192
    s_add_u32 s74, s60, 720896
    buffer_load_dwordx4 v9, s[44:47], s74 offen offset:0 lds
    buffer_load_dwordx4 v10, s[44:47], s74 offen offset:1024 lds
    s_add_u32 m0, s14, 16384
    s_add_u32 s74, s60, 1179648
    buffer_load_dwordx4 v9, s[44:47], s74 offen offset:0 lds
    buffer_load_dwordx4 v10, s[44:47], s74 offen offset:1024 lds
    s_add_u32 m0, s14, 24576
    s_add_u32 s74, s60, 1638400
    buffer_load_dwordx4 v9, s[44:47], s74 offen offset:0 lds
    buffer_load_dwordx4 v10, s[44:47], s74 offen offset:1024 lds
    s_add_u32 m0, s14, 106496
    s_add_u32 s74, s60, 1441792
    buffer_load_dwordx4 v9, s[44:47], s74 offen offset:0 lds
    buffer_load_dwordx4 v10, s[44:47], s74 offen offset:1024 lds
    s_add_u32 m0, s14, 32768
    s_add_u32 s74, s60, 327680
    buffer_load_dwordx4 v9, s[44:47], s74 offen offset:0 lds
    buffer_load_dwordx4 v10, s[44:47], s74 offen offset:1024 lds
    s_waitcnt lgkmcnt(0)
    s_barrier
    s_lshl_b32 s70, s3, 2
    v_add_u32_e64 v25, s70, v17
    v_mov_b32 v24, -1
    s_add_u32 m0, s14, 81920
    s_add_u32 s74, s60, 65536
    buffer_load_dwordx4 v9, s[44:47], s74 offen offset:0 lds
    s_waitcnt vmcnt(8)
    buffer_load_dwordx4 v10, s[44:47], s74 offen offset:1024 lds
    s_waitcnt vmcnt(8)
    s_add_u32 m0, s14, 40960
    s_add_u32 s74, s60, 786432
    buffer_load_dwordx4 v9, s[44:47], s74 offen offset:0 lds
    s_waitcnt vmcnt(8)
    buffer_load_dwordx4 v10, s[44:47], s74 offen offset:1024 lds
    s_waitcnt vmcnt(8)
    s_add_u32 m0, s14, 49152
    s_add_u32 s74, s60, 1245184
    buffer_load_dwordx4 v9, s[44:47], s74 offen offset:0 lds
    s_waitcnt vmcnt(8)
    buffer_load_dwordx4 v10, s[44:47], s74 offen offset:1024 lds
    s_waitcnt vmcnt(8)
    s_add_u32 m0, s14, 57344
    s_add_u32 s74, s60, 1703936
    buffer_load_dwordx4 v9, s[44:47], s74 offen offset:0 lds
    s_waitcnt vmcnt(8)
    buffer_load_dwordx4 v10, s[44:47], s74 offen offset:1024 lds
    s_waitcnt vmcnt(8)
    s_add_u32 s74, s60, 131072
    buffer_load_dwordx4 v[96:99], v9, s[44:47], s74 offen offset:0
    s_waitcnt vmcnt(8)
    buffer_load_dwordx4 v[100:103], v10, s[44:47], s74 offen offset:1024
    s_waitcnt vmcnt(8)
    s_add_u32 s74, s60, 589824
    buffer_load_dwordx4 v[104:107], v9, s[44:47], s74 offen offset:0
    s_waitcnt vmcnt(8)
    buffer_load_dwordx4 v[108:111], v10, s[44:47], s74 offen offset:1024
    s_waitcnt vmcnt(8)
    s_add_u32 s74, s60, 1048576
    buffer_load_dwordx4 v[112:115], v9, s[44:47], s74 offen offset:0
    s_waitcnt vmcnt(8)
    buffer_load_dwordx4 v[116:119], v10, s[44:47], s74 offen offset:1024
    s_waitcnt vmcnt(8)
    s_add_u32 s74, s60, 1507328
    buffer_load_dwordx4 v[120:123], v9, s[44:47], s74 offen offset:0
    s_waitcnt vmcnt(8)
    buffer_load_dwordx4 v[124:127], v10, s[44:47], s74 offen offset:1024
    s_waitcnt vmcnt(8)
    s_add_u32 s74, s60, 393216
    buffer_load_dwordx4 v[128:131], v9, s[44:47], s74 offen offset:0
    s_waitcnt vmcnt(8)
    buffer_load_dwordx4 v[132:135], v10, s[44:47], s74 offen offset:1024
    s_waitcnt vmcnt(8)
    s_add_u32 s74, s60, 851968
    buffer_load_dwordx4 v[136:139], v9, s[44:47], s74 offen offset:0
    s_waitcnt vmcnt(8)
    buffer_load_dwordx4 v[140:143], v10, s[44:47], s74 offen offset:1024
    s_waitcnt vmcnt(8)
    s_waitcnt vmcnt(12)
    s_nop 0
    ds_write_b32 v25, v24 offset:16
    s_add_u32 s74, s60, 1310720
    buffer_load_dwordx4 v[144:147], v9, s[44:47], s74 offen offset:0
    s_waitcnt vmcnt(8)
    buffer_load_dwordx4 v[148:151], v10, s[44:47], s74 offen offset:1024
    s_waitcnt vmcnt(8)
    s_add_u32 s74, s60, 1769472
    buffer_load_dwordx4 v[152:155], v9, s[44:47], s74 offen offset:0
    s_waitcnt vmcnt(8)
    buffer_load_dwordx4 v[156:159], v10, s[44:47], s74 offen offset:1024
    s_waitcnt vmcnt(8)
    s_add_u32 s74, s60, 196608
    buffer_load_dwordx4 v[160:163], v9, s[44:47], s74 offen offset:0
    s_waitcnt vmcnt(8)
    buffer_load_dwordx4 v[164:167], v10, s[44:47], s74 offen offset:1024
    s_waitcnt vmcnt(8)
    s_add_u32 s74, s60, 655360
    buffer_load_dwordx4 v[168:171], v9, s[44:47], s74 offen offset:0
    s_waitcnt vmcnt(8)
    buffer_load_dwordx4 v[172:175], v10, s[44:47], s74 offen offset:1024
    s_waitcnt vmcnt(8)
    s_add_u32 s74, s60, 1114112
    buffer_load_dwordx4 v[176:179], v9, s[44:47], s74 offen offset:0
    s_waitcnt vmcnt(8)
    buffer_load_dwordx4 v[180:183], v10, s[44:47], s74 offen offset:1024
    s_waitcnt vmcnt(8)
    s_add_u32 s74, s60, 1572864
    buffer_load_dwordx4 v[184:187], v9, s[44:47], s74 offen offset:0
    s_waitcnt vmcnt(8)
    buffer_load_dwordx4 v[188:191], v10, s[44:47], s74 offen offset:1024
    s_waitcnt vmcnt(8)
    s_add_u32 s74, s60, 0
    buffer_load_dwordx4 v[192:195], v9, s[48:51], s74 offen offset:0
    s_waitcnt vmcnt(8)
    buffer_load_dwordx4 v[196:199], v10, s[48:51], s74 offen offset:1024
    s_waitcnt vmcnt(8)
    s_add_u32 s74, s60, 131072
    buffer_load_dwordx4 v[200:203], v9, s[48:51], s74 offen offset:0
    s_waitcnt vmcnt(8)
    buffer_load_dwordx4 v[204:207], v10, s[48:51], s74 offen offset:1024
    s_waitcnt vmcnt(8)
    s_add_u32 s74, s60, 262144
    buffer_load_dwordx4 v[208:211], v9, s[48:51], s74 offen offset:0
    s_waitcnt vmcnt(8)
    buffer_load_dwordx4 v[212:215], v10, s[48:51], s74 offen offset:1024
    s_waitcnt vmcnt(8)
    s_add_u32 s74, s60, 393216
    buffer_load_dwordx4 v[216:219], v9, s[48:51], s74 offen offset:0
    s_waitcnt vmcnt(8)
    buffer_load_dwordx4 v[220:223], v10, s[48:51], s74 offen offset:1024
    s_waitcnt vmcnt(8)
    s_add_u32 s74, s60, 65536
    buffer_load_dwordx4 v[224:227], v9, s[48:51], s74 offen offset:0
    s_waitcnt vmcnt(8)
    buffer_load_dwordx4 v[228:231], v10, s[48:51], s74 offen offset:1024
    s_waitcnt vmcnt(8)
    s_add_u32 s74, s60, 196608
    buffer_load_dwordx4 v[232:235], v9, s[48:51], s74 offen offset:0
    s_waitcnt vmcnt(8)
    buffer_load_dwordx4 v[236:239], v10, s[48:51], s74 offen offset:1024
    s_waitcnt vmcnt(8)
    s_add_u32 s74, s60, 327680
    buffer_load_dwordx4 v[240:243], v9, s[48:51], s74 offen offset:0
    s_waitcnt vmcnt(8)
    buffer_load_dwordx4 v[244:247], v10, s[48:51], s74 offen offset:1024
    s_waitcnt vmcnt(8)
    s_add_u32 s74, s60, 458752
    buffer_load_dwordx4 v[248:251], v9, s[48:51], s74 offen offset:0
    s_waitcnt vmcnt(8)
    buffer_load_dwordx4 v[252:255], v10, s[48:51], s74 offen offset:1024
    s_waitcnt vmcnt(8)
    v_add_u32 v11, s14, v11
    v_add_u32 v20, 114688, v11
    v_add_u32_e64 v21, 0, v11
    v_add_u32 v22, 81920, v11
    v_add_u32 v23, 32768, v11
    s_mov_b32 s79, 2000000
L_free_13:
    ds_read_b128 v[24:27], v17 offset:64
    s_waitcnt lgkmcnt(0)
    v_and_b32 v24, v24, v25
    v_and_b32 v26, v26, v27
    v_and_b32 v24, v24, v26
    s_nop 0
    v_readfirstlane_b32 s70, v24
    s_nop 0
    s_cmp_lg_u32 s70, 0
    s_cbranch_scc1 L_freed_14
    s_sub_u32 s79, s79, 1
    s_cmp_eq_u32 s79, 0
    s_cbranch_scc1 L_freed_14
    s_sleep 1
    s_branch L_free_13
L_freed_14:
    ds_write_b128 v20, v[96:99] offset:0
    ds_write_b128 v20, v[100:103] offset:1024
    ds_write_b128 v20, v[104:107] offset:8192
    ds_write_b128 v20, v[108:111] offset:9216
    ds_write_b128 v20, v[112:115] offset:16384
    ds_write_b128 v20, v[116:119] offset:17408
    ds_write_b128 v20, v[120:123] offset:24576
    ds_write_b128 v20, v[124:127] offset:25600
    ds_write_b128 v21, v[128:131] offset:0
    ds_write_b128 v21, v[132:135] offset:1024
    ds_write_b128 v21, v[136:139] offset:8192
    ds_write_b128 v21, v[140:143] offset:9216
    ds_write_b128 v21, v[144:147] offset:16384
    ds_write_b128 v21, v[148:151] offset:17408
    ds_write_b128 v21, v[152:155] offset:24576
    ds_write_b128 v21, v[156:159] offset:25600
    ds_write_b128 v22, v[160:163] offset:0
    ds_write_b128 v22, v[164:167] offset:1024
    ds_write_b128 v22, v[168:171] offset:8192
    ds_write_b128 v22, v[172:175] offset:9216
    ds_write_b128 v22, v[176:179] offset:16384
    ds_write_b128 v22, v[180:183] offset:17408
    ds_write_b128 v22, v[184:187] offset:24576
    ds_write_b128 v22, v[188:191] offset:25600
    s_waitcnt vmcnt(0) lgkmcnt(0)
    s_barrier
    ds_write_b128 v23, v[192:195] offset:0
    ds_write_b128 v23, v[196:199] offset:1024
    ds_write_b128 v23, v[200:203] offset:8192
    ds_write_b128 v23, v[204:207] offset:9216
    s_barrier
    s_nop 0
    ds_write_b128 v23, v[208:211] offset:16384
    ds_write_b128 v23, v[212:215] offset:17408
    ds_write_b128 v23, v[216:219] offset:24576
    ds_write_b128 v23, v[220:223] offset:25600
    ds_write_b128 v20, v[224:227] offset:0
    ds_write_b128 v20, v[228:231] offset:1024
    ds_write_b128 v20, v[232:235] offset:8192
    ds_write_b128 v20, v[236:239] offset:9216
    ds_write_b128 v20, v[240:243] offset:16384
    ds_write_b128 v20, v[244:247] offset:17408
    ds_write_b128 v20, v[248:251] offset:24576
    ds_write_b128 v20, v[252:255] offset:25600
    s_waitcnt vmcnt(0) lgkmcnt(0)
    s_barrier
    s_endpgm
L_compute:
    s_and_b32 s8, s2, 7
    s_lshl_b32 s8, s8, 2
    s_lshr_b32 s70, s2, 6
    s_add_u32 s8, s8, s70
    s_mov_b32 s71, 1696023043
    s_cmp_eq_u32 s70, 1
    s_cselect_b32 s71, 1699156003, s71
    s_cmp_eq_u32 s70, 2
    s_cselect_b32 s71, 1114050643, s71
    s_cmp_eq_u32 s70, 3
    s_cselect_b32 s71, 1699160323, s71
    s_and_b32 s9, s10, 7
    s_lshl_b32 s9, s9, 2
    s_lshr_b32 s9, s71, s9
    s_and_b32 s9, s9, 7
    s_lshl_b32 s64, s6, 11
    s_add_u32 s64, s64, 149504
    v_lshrrev_b32 v227, 4, v0
    v_add_u32 v226, 73728, v225
    s_mov_b32 s52, s34
    s_mov_b32 s53, s35
    s_mov_b32 s54, 11534336
    s_mov_b32 s55, 0x20000
    s_mov_b32 s56, s30
    s_mov_b32 s57, s31
    s_mov_b32 s58, 2097152
    s_mov_b32 s59, 0x20000
    s_lshl_b32 s70, s12, 2
    v_bfe_u32 v2, v0, 1, 3
    v_xor_b32 v2, v227, v2
    v_xor_b32 v2, s70, v2
    s_lshl_b32 s70, s11, 13
    s_lshl_b32 s71, s12, 12
    s_add_u32 s70, s70, s71
    v_lshlrev_b32 v3, 7, v228
    v_add_u32 v3, s70, v3
    v_lshl_add_u32 v212, v2, 4, v3
    v_xor_b32 v213, 0x1000, v212
    v_xor_b32 v214, 64, v212
    v_xor_b32 v215, 64, v213
    v_bfe_u32 v2, v0, 2, 2
    v_lshl_add_u32 v2, v227, 3, v2
    s_lshl_b32 s70, s12, 5
    v_add_u32 v2, s70, v2
    v_and_b32 v4, 3, v0
    v_cmp_eq_u32 vcc, 0, v4
    v_lshlrev_b32 v4, 3, v4
    v_bfe_u32 v3, v0, 3, 2
    v_xor_b32 v7, s3, v3
    v_lshl_add_u32 v7, v7, 5, v4
    v_lshl_add_u32 v7, v2, 7, v7
    v_add_u32 v216, 16384, v7
    v_xor_b32_e64 v217, 32, v216
    v_xor_b32 v218, 0x1000, v216
    v_xor_b32 v219, 0x1000, v217
    v_lshl_add_u32 v6, v5, 5, v4
    v_lshl_add_u32 v6, v2, 6, v6
    v_add_u32 v220, 40960, v6
    v_xor_b32 v221, 32, v220
    v_xor_b32 v222, 0x800, v220
    v_xor_b32 v223, 0x800, v221
    v_lshrrev_b32 v2, 2, v0
    v_lshl_add_u32 v4, v3, 5, v4
    v_lshl_add_u32 v4, v2, 7, v4
    s_lshl_b32 s70, s3, 13
    v_add_u32 v15, s70, v4
    v_mov_b32 v3, 0x3f803f80
    v_cndmask_b32 v208, 0, v3, vcc
    v_mov_b32 v209, v208
    v_mov_b32 v210, v208
    v_mov_b32 v211, v208
    s_lshl_b32 s70, s4, 1
    s_add_u32 s70, s70, s11
    s_mul_i32 s72, s70, 8192
    s_lshl_b32 s70, s70, 1
    s_add_u32 s70, s70, s12
    s_xor_b32 s71, s70, 1
    s_mul_i32 s76, s70, 147456
    s_mul_i32 s77, s71, 147456
    s_lshr_b32 s70, s5, 1
    s_mul_i32 s70, s70, 256
    s_add_u32 s72, s72, s70
    s_and_b32 s70, s5, 1
    s_lshl_b32 s70, s70, 1
    s_add_u32 s70, s70, s12
    s_lshl_b32 s70, s70, 2
    s_add_u32 s72, s72, s70
    s_xor_b32 s70, s6, 1
    s_mul_i32 s70, s70, 1024
    s_add_u32 s72, s72, s70
    s_add_u32 s72, s72, 1048576
    s_add_u32 s66, s34, s72
    s_addc_u32 s67, s35, 0
    s_mul_i32 s70, s8, 8192
    s_mul_i32 s71, s3, 256
    s_add_u32 s70, s70, s71
    s_add_u32 s70, s70, 1048576
    s_add_u32 s40, s34, s70
    s_addc_u32 s41, s35, 0
    s_mov_b32 s14, 0
    s_mov_b32 s15, 0
    s_mov_b32 s22, -90112
    s_mov_b32 s23, 0xffff0000
    s_lshl_b32 s70, s8, 2
    s_add_u32 s71, s70, s3
    s_lshl_b32 s71, s71, 14
    s_lshl_b32 s72, s9, 7
    s_add_u32 s18, s71, s72
    v_bfe_u32 v2, v0, 4, 1
    v_lshrrev_b32 v3, 5, v0
    v_lshlrev_b32 v14, 4, v3
    v_lshl_add_u32 v3, v2, 5, v14
    v_lshl_add_u32 v1, v228, 10, v3
    s_mul_i32 s70, s70, 73728
    s_add_u32 s70, s70, 2097152
    s_or_b32 s19, s2, s3
    s_mul_i32 s71, s3, 14336
    s_add_u32 s16, s70, s71
    s_lshl_b32 s71, s3, 12
    s_add_u32 s17, s70, s71
    s_add_u32 s17, s17, 57344
    s_add_u32 s70, s3, 1
    s_and_b32 s70, s70, 3
    s_mul_i32 s70, s70, 73728
    v_add_u32 v248, s70, v225
    s_add_u32 s70, s3, 2
    s_and_b32 s70, s70, 3
    s_mul_i32 s70, s70, 73728
    v_add_u32 v249, s70, v225
    s_add_u32 s70, s3, 3
    s_and_b32 s70, s70, 3
    s_mul_i32 s70, s70, 73728
    v_add_u32 v250, s70, v225
    s_add_u32 s70, s3, 4
    s_and_b32 s70, s70, 3
    s_mul_i32 s70, s70, 73728
    v_add_u32_e64 v251, s70, v225
    v_mov_b32 v52, 0
    v_mov_b32 v53, 0
    v_mov_b32 v54, 0
    v_mov_b32 v55, 0
    v_mov_b32 v60, 0
    v_mov_b32 v61, 0
    v_mov_b32 v62, 0
    v_mov_b32 v63, 0
    v_mov_b32 v68, 0
    v_mov_b32 v69, 0
    v_mov_b32 v70, 0
    v_mov_b32 v71, 0
    v_mov_b32 v76, 0
    v_mov_b32 v77, 0
    v_mov_b32 v78, 0
    v_mov_b32 v79, 0
    v_mov_b32 v84, 0
    v_mov_b32 v85, 0
    v_mov_b32 v86, 0
    v_mov_b32 v87, 0
    v_mov_b32 v92, 0
    v_mov_b32 v93, 0
    v_mov_b32 v94, 0
    v_mov_b32 v95, 0
    v_mov_b32 v100, 0
    v_mov_b32 v101, 0
    v_mov_b32 v102, 0
    v_mov_b32 v103, 0
    v_mov_b32 v108, 0
    v_mov_b32 v109, 0
    v_mov_b32 v110, 0
    v_mov_b32 v111, 0
    s_waitcnt lgkmcnt(0)
    s_mul_i32 s74, s68, 0x4c957f2d
    s_mul_hi_u32 s75, s68, 0x4c957f2d
    s_mul_i32 s70, s69, 0x4c957f2d
    s_add_u32 s75, s75, s70
    s_mul_i32 s70, s68, 0x5851f42d
    s_add_u32 s75, s75, s70
    s_add_u32 s68, s74, 0xf767814f
    s_addc_u32 s69, s75, 0x14057b7e
    s_mov_b32 s42, s68
    s_mov_b32 s43, s68
    v_mov_b32 v12, s68
    v_mov_b32 v13, s69
    v_mov_b32 v2, s64
    s_lshl_b32 s70, s3, 2
    v_add_u32 v229, s70, v2
    v_mov_b32 v3, 0
    ds_write_b64 v2, v[12:13]
    ds_write_b32 v229, v3 offset:16
    ds_write_b32 v229, v3 offset:32
    ds_write_b32 v229, v3 offset:48
    ds_write_b32 v229, v3 offset:64
    s_waitcnt vmcnt(2)
    v_lshlrev_b32 v2, 16, v128
    v_and_b32 v3, s23, v128
    v_add_f32 v136, v2, v3
    v_mul_f32 v137, v2, v2
    v_fmac_f32 v137, v3, v3
    v_lshlrev_b32 v2, 16, v129
    v_and_b32 v3, s23, v129
    v_add_f32 v136, v136, v2
    v_fmac_f32 v137, v2, v2
    v_add_f32 v136, v136, v3
    v_fmac_f32 v137, v3, v3
    v_lshlrev_b32 v2, 16, v130
    v_and_b32 v3, s23, v130
    v_add_f32 v136, v136, v2
    v_fmac_f32 v137, v2, v2
    v_add_f32 v136, v136, v3
    v_fmac_f32 v137, v3, v3
    v_lshlrev_b32 v2, 16, v131
    v_and_b32 v3, s23, v131
    v_add_f32 v136, v136, v2
    v_fmac_f32 v137, v2, v2
    v_add_f32 v136, v136, v3
    v_fmac_f32 v137, v3, v3
    v_lshlrev_b32 v2, 16, v132
    v_and_b32 v3, s23, v132
    v_add_f32 v138, v2, v3
    v_mul_f32 v139, v2, v2
    v_fmac_f32 v139, v3, v3
    v_lshlrev_b32 v2, 16, v133
    v_and_b32 v3, s23, v133
    v_add_f32 v138, v138, v2
    v_fmac_f32 v139, v2, v2
    v_add_f32 v138, v138, v3
    v_fmac_f32 v139, v3, v3
    v_lshlrev_b32 v2, 16, v134
    v_and_b32 v3, s23, v134
    v_add_f32 v138, v138, v2
    v_fmac_f32 v139, v2, v2
    v_add_f32 v138, v138, v3
    v_fmac_f32 v139, v3, v3
    v_lshlrev_b32 v2, 16, v135
    v_and_b32 v3, s23, v135
    v_add_f32 v138, v138, v2
    v_fmac_f32 v139, v2, v2
    v_add_f32 v138, v138, v3
    v_fmac_f32 v139, v3, v3
    s_nop 0
    v_permlane32_swap_b32 v136, v138
    v_permlane32_swap_b32 v137, v139
    v_add_f32 v136, v136, v138
    v_add_f32 v137, v137, v139
    v_mov_b32 v138, v136
    v_mov_b32 v139, v137
    s_nop 0
    v_permlane16_swap_b32 v138, v136
    v_permlane16_swap_b32 v139, v137
    v_add_f32 v136, v136, v138
    v_add_f32 v137, v137, v139
    s_nop 0
    v_add_f32_dpp v136, v136, v136 row_ror:1 row_mask:0xf bank_mask:0xf
    v_add_f32_dpp v137, v137, v137 row_ror:1 row_mask:0xf bank_mask:0xf
    s_nop 0
    v_add_f32_dpp v136, v136, v136 row_ror:2 row_mask:0xf bank_mask:0xf
    v_add_f32_dpp v137, v137, v137 row_ror:2 row_mask:0xf bank_mask:0xf
    s_nop 0
    v_add_f32_dpp v136, v136, v136 row_ror:4 row_mask:0xf bank_mask:0xf
    v_add_f32_dpp v137, v137, v137 row_ror:4 row_mask:0xf bank_mask:0xf
    s_nop 0
    s_nop 0
    v_add_f32_dpp v136, v136, v136 row_ror:8 row_mask:0xf bank_mask:0xf
    v_add_f32_dpp v137, v137, v137 row_ror:8 row_mask:0xf bank_mask:0xf
    v_mul_f32 v2, 0xbb000000, v136
    v_mul_f32 v3, 0x3b000000, v137
    v_fma_f32 v3, -v2, v2, v3
    v_max_f32 v3, 0, v3
    v_add_f32 v3, 0x3727c5ac, v3
    v_rsq_f32 v3, v3
    s_lshl_b32 s70, s3, 5
    s_add_u32 s70, s70, s64
    v_add_u32 v4, s70, v14
    v_mul_f32 v10, 0x3fb8aa3b, v3
    v_mul_f32 v11, v10, v2
    v_bfi_b32 v10, 1, v12, v10
    v_bfi_b32 v11, 1, v12, v11
    s_mov_b32 exec_lo, 1
    s_mov_b32 exec_hi, 1
    ds_write_b128 v4, v[10:13] offset:128
    s_mov_b64 exec, -1
    s_lshl_b32 s74, s11, 8
    s_lshl_b32 s71, s12, 7
    s_add_u32 s74, s74, s71
    s_add_u32 s74, s74, 147456
    s_lshl_b32 s70, s12, 9
    s_lshl_b32 s71, s11, 6
    s_add_u32 s70, s70, s71
    s_nop 0
    s_add_u32 s70, s70, 148480
    v_lshl_add_u32 v2, v228, 2, s74
    v_xor_b32 v3, 128, v2
    v_lshl_add_u32 v4, v227, 4, s70
    v_xor_b32 v5, 64, v4
    v_lshl_add_u32 v224, v228, 2, s70
    s_cmp_eq_u32 s6, 0
    s_cbranch_scc1 L_compute_A
    s_lshl_b32 s78, s78, 5
    s_add_u32 s78, s78, s76
    s_add_u32 s78, s78, 2097152
    s_lshl_b32 s72, s65, 5
    s_add_u32 s72, s72, 2097152
    s_lshl_b32 s70, s3, 9
    s_nop 0
    s_add_u32 s70, s70, 149504
    v_lshl_add_u32 v7, v0, 2, s70
    v_lshl_add_u32 v6, v227, 4, s70
    s_waitcnt vmcnt(0)
    v_lshlrev_b32_e64 v8, 16, v8
    v_lshlrev_b32 v9, 16, v9
    v_mul_f32 v8, 0x3fb8aa3b, v8
    v_mul_f32 v9, 0x3fb8aa3b, v9
    ds_write_b32 v7, v8
    ds_write_b32 v7, v9 offset:256
    v_xor_b32 v7, 0x200, v4
    v_xor_b32 v14, 0x200, v5
    v_mov_b32 v232, 0xbfb17218
    v_mov_b32 v233, 0x3f317218
    s_add_u32 s76, s76, s72
    s_add_u32 s77, s77, s72
    s_add_u32 s70, s76, 2048
    s_add_u32 s71, s77, 2048
    s_add_u32 s72, s76, 4096
    s_add_u32 s73, s77, 4096
    s_waitcnt lgkmcnt(0)
    s_barrier
    ds_read_b64_tr_b16 v[160:161], v216 offset:0
    ds_read_b64_tr_b16 v[162:163], v216 offset:512
    ds_read_b64_tr_b16 v[164:165], v218 offset:0
    ds_read_b64_tr_b16 v[166:167], v218 offset:512
    ds_read_b64_tr_b16 v[168:169], v216 offset:8192
    ds_read_b128 v[128:131], v212 offset:0
    ds_read_b128 v[132:135], v214 offset:0
    ds_read_b64_tr_b16 v[170:171], v216 offset:8704
    ds_read_b128 v[136:139], v212 offset:2048
    ds_read_b128 v[140:143], v214 offset:2048
    ds_read_b64_tr_b16 v[172:173], v218 offset:8192
    ds_read_b128 v[144:147], v213 offset:0
    ds_read_b128 v[148:151], v215 offset:0
    ds_read_b64_tr_b16 v[174:175], v218 offset:8704
    ds_read_b128 v[152:155], v213 offset:2048
    ds_read_b128 v[156:159], v215 offset:2048
    s_waitcnt lgkmcnt(12)
    v_mfma_f32_16x16x32_bf16 v[192:195], v[208:211], v[160:163], 0
    ds_read_b64_tr_b16 v[176:177], v216 offset:16384
    v_mfma_f32_16x16x32_bf16 v[192:195], v[208:211], v[164:167], v[192:195]
    ds_read_b64_tr_b16 v[178:179], v216 offset:16896
    s_waitcnt lgkmcnt(11)
    v_mfma_f32_16x16x32_bf16 v[16:19], v[160:163], v[128:131], 0
    ds_read_b64_tr_b16 v[180:181], v218 offset:16384
    v_mfma_f32_16x16x32_bf16 v[16:19], v[164:167], v[132:135], v[16:19]
    ds_read_b64_tr_b16 v[182:183], v218 offset:16896
    s_waitcnt lgkmcnt(10)
    v_mfma_f32_16x16x32_bf16 v[24:27], v[160:163], v[136:139], 0
    s_add_u32 s15, s15, 1
    v_mfma_f32_16x16x32_bf16 v[24:27], v[164:167], v[140:143], v[24:27]
    s_cmp_eq_u32 s15, 3
    s_waitcnt lgkmcnt(7)
    v_mfma_f32_16x16x32_bf16 v[32:35], v[160:163], v[144:147], 0
    s_cselect_b32 s13, s22, 45056
    v_mfma_f32_16x16x32_bf16 v[32:35], v[164:167], v[148:151], v[32:35]
    s_cselect_b32 s15, 0, s15
    s_waitcnt lgkmcnt(4)
    v_mfma_f32_16x16x32_bf16 v[40:43], v[160:163], v[152:155], 0
    v_mfma_f32_16x16x32_bf16 v[40:43], v[164:167], v[156:159], v[40:43]
    s_waitcnt lgkmcnt(6)
    v_mfma_f32_16x16x32_bf16 v[196:199], v[208:211], v[168:171], 0
    ds_write_b32 v224, v192 offset:0
    v_mfma_f32_16x16x32_bf16 v[196:199], v[208:211], v[172:175], v[196:199]
    ds_read_b64_tr_b16 v[184:185], v220 offset:0
    v_mfma_f32_16x16x32_bf16 v[48:51], v[168:171], v[128:131], 0
    ds_read_b64_tr_b16 v[186:187], v220 offset:256
    v_mfma_f32_16x16x32_bf16 v[48:51], v[172:175], v[132:135], v[48:51]
    ds_read_b64_tr_b16 v[188:189], v222 offset:0
    v_mfma_f32_16x16x32_bf16 v[56:59], v[168:171], v[136:139], 0
    ds_read_b64_tr_b16 v[190:191], v222 offset:256
    v_mfma_f32_16x16x32_bf16 v[56:59], v[172:175], v[140:143], v[56:59]
    v_add_u32 v216, s13, v216
    v_mfma_f32_16x16x32_bf16 v[64:67], v[168:171], v[144:147], 0
    v_add_u32 v218, s13, v218
    v_mfma_f32_16x16x32_bf16 v[64:67], v[172:175], v[148:151], v[64:67]
    v_add_u32 v212, s13, v212
    v_mfma_f32_16x16x32_bf16 v[72:75], v[168:171], v[152:155], 0
    v_add_u32 v213, s13, v213
    v_mfma_f32_16x16x32_bf16 v[72:75], v[172:175], v[156:159], v[72:75]
    s_waitcnt lgkmcnt(5)
    v_mfma_f32_16x16x32_bf16 v[200:203], v[208:211], v[176:179], 0
    ds_write_b32 v224, v196 offset:128
    v_mfma_f32_16x16x32_bf16 v[200:203], v[208:211], v[180:183], v[200:203]
    ds_read_b64_tr_b16 v[160:161], v221 offset:0
    v_mfma_f32_16x16x32_bf16 v[80:83], v[176:179], v[128:131], 0
    ds_read_b64_tr_b16 v[162:163], v221 offset:256
    v_mfma_f32_16x16x32_bf16 v[80:83], v[180:183], v[132:135], v[80:83]
    ds_read_b64_tr_b16 v[164:165], v223 offset:0
    v_mfma_f32_16x16x32_bf16 v[88:91], v[176:179], v[136:139], 0
    ds_read_b64_tr_b16 v[166:167], v223 offset:256
    v_mfma_f32_16x16x32_bf16 v[88:91], v[180:183], v[140:143], v[88:91]
    v_add_u32 v214, s13, v214
    v_mfma_f32_16x16x32_bf16 v[96:99], v[176:179], v[144:147], 0
    v_add_u32 v215, s13, v215
    v_mfma_f32_16x16x32_bf16 v[96:99], v[180:183], v[148:151], v[96:99]
    v_mfma_f32_16x16x32_bf16 v[104:107], v[176:179], v[152:155], 0
    v_mfma_f32_16x16x32_bf16 v[104:107], v[180:183], v[156:159], v[104:107]
    s_waitcnt lgkmcnt(5)
    v_mfma_f32_16x16x32_bf16 v[204:207], v[208:211], v[184:187], 0
    ds_write_b32 v224, v200 offset:256
    v_mfma_f32_16x16x32_bf16 v[112:115], v[184:187], v[128:131], 0
    ds_read_b64_tr_b16 v[168:169], v217 offset:0
    v_mfma_f32_16x16x32_bf16 v[112:115], v[188:191], v[132:135], v[112:115]
    ds_read_b64_tr_b16 v[170:171], v217 offset:512
    v_mfma_f32_16x16x32_bf16 v[120:123], v[184:187], v[136:139], 0
    ds_read_b64_tr_b16 v[172:173], v219 offset:0
    v_mfma_f32_16x16x32_bf16 v[120:123], v[188:191], v[140:143], v[120:123]
    ds_read_b64_tr_b16 v[174:175], v219 offset:512
    s_waitcnt lgkmcnt(5)
    v_mfma_f32_16x16x32_bf16 v[116:119], v[160:163], v[128:131], 0
    ds_write_b32 v224, v204 offset:384
    ds_read_b64_tr_b16 v[176:177], v217 offset:8192
    v_mfma_f32_16x16x32_bf16 v[116:119], v[164:167], v[132:135], v[116:119]
    ds_read_b64_tr_b16 v[178:179], v217 offset:8704
    v_mfma_f32_16x16x32_bf16 v[124:127], v[160:163], v[136:139], 0
    ds_read_b64_tr_b16 v[180:181], v219 offset:8192
    v_mfma_f32_16x16x32_bf16 v[124:127], v[164:167], v[140:143], v[124:127]
    ds_read_b64_tr_b16 v[182:183], v219 offset:8704
    s_waitcnt lgkmcnt(5)
    v_mfma_f32_16x16x32_bf16 v[20:23], v[168:171], v[128:131], 0
    ds_read_b64_tr_b16 v[184:185], v217 offset:16384
    v_mfma_f32_16x16x32_bf16 v[20:23], v[172:175], v[132:135], v[20:23]
    ds_read_b64_tr_b16 v[186:187], v217 offset:16896
    v_mfma_f32_16x16x32_bf16 v[28:31], v[168:171], v[136:139], 0
    ds_read_b64_tr_b16 v[188:189], v219 offset:16384
    v_mfma_f32_16x16x32_bf16 v[28:31], v[172:175], v[140:143], v[28:31]
    ds_read_b64_tr_b16 v[190:191], v219 offset:16896
    v_mfma_f32_16x16x32_bf16 v[36:39], v[168:171], v[144:147], 0
    v_add_u32 v220, s13, v220
    v_mfma_f32_16x16x32_bf16 v[36:39], v[172:175], v[148:151], v[36:39]
    v_add_u32 v221, s13, v221
    v_mfma_f32_16x16x32_bf16 v[44:47], v[168:171], v[152:155], 0
    v_add_u32 v222, s13, v222
    v_mfma_f32_16x16x32_bf16 v[44:47], v[172:175], v[156:159], v[44:47]
    v_add_u32 v223, s13, v223
    s_waitcnt lgkmcnt(4)
    v_mfma_f32_16x16x32_bf16 v[52:55], v[176:179], v[128:131], v[52:55]
    v_mfma_f32_16x16x32_bf16 v[52:55], v[180:183], v[132:135], v[52:55]
L_kloop_15:
    s_waitcnt lgkmcnt(0)
    s_barrier
    v_mfma_f32_16x16x32_bf16 v[60:63], v[176:179], v[136:139], v[60:63]
    ds_read_b64_tr_b16 v[160:161], v216 offset:0
    v_mfma_f32_16x16x32_bf16 v[60:63], v[180:183], v[140:143], v[60:63]
    ds_read_b64_tr_b16 v[162:163], v216 offset:512
    v_mfma_f32_16x16x32_bf16 v[68:71], v[176:179], v[144:147], v[68:71]
    ds_read_b64_tr_b16 v[164:165], v218 offset:0
    v_mfma_f32_16x16x32_bf16 v[68:71], v[180:183], v[148:151], v[68:71]
    ds_read_b64_tr_b16 v[166:167], v218 offset:512
    v_mfma_f32_16x16x32_bf16 v[76:79], v[176:179], v[152:155], v[76:79]
    v_add_u32 v217, s13, v217
    v_mfma_f32_16x16x32_bf16 v[76:79], v[180:183], v[156:159], v[76:79]
    v_add_u32 v219, s13, v219
    v_mfma_f32_16x16x32_bf16 v[84:87], v[184:187], v[128:131], v[84:87]
    ds_read_b64_tr_b16 v[168:169], v216 offset:8192
    v_mfma_f32_16x16x32_bf16 v[84:87], v[188:191], v[132:135], v[84:87]
    ds_read_b128 v[128:131], v212 offset:0
    ds_read_b128 v[132:135], v214 offset:0
    v_mfma_f32_16x16x32_bf16 v[92:95], v[184:187], v[136:139], v[92:95]
    ds_read_b64_tr_b16 v[170:171], v216 offset:8704
    v_mfma_f32_16x16x32_bf16 v[92:95], v[188:191], v[140:143], v[92:95]
    ds_read_b128 v[136:139], v212 offset:2048
    ds_read_b128 v[140:143], v214 offset:2048
    v_mfma_f32_16x16x32_bf16 v[100:103], v[184:187], v[144:147], v[100:103]
    ds_read_b64_tr_b16 v[172:173], v218 offset:8192
    v_mfma_f32_16x16x32_bf16 v[100:103], v[188:191], v[148:151], v[100:103]
    ds_read_b128 v[144:147], v213 offset:0
    ds_read_b128 v[148:151], v215 offset:0
    v_mfma_f32_16x16x32_bf16 v[108:111], v[184:187], v[152:155], v[108:111]
    ds_read_b64_tr_b16 v[174:175], v218 offset:8704
    v_mfma_f32_16x16x32_bf16 v[108:111], v[188:191], v[156:159], v[108:111]
    ds_read_b128 v[152:155], v213 offset:2048
    ds_read_b128 v[156:159], v215 offset:2048
    s_waitcnt lgkmcnt(12)
    s_waitcnt lgkmcnt(9)
    v_mfma_f32_16x16x32_bf16 v[16:19], v[160:163], v[128:131], v[16:19]
    ds_read_b64_tr_b16 v[176:177], v216 offset:16384
    v_mfma_f32_16x16x32_bf16 v[16:19], v[164:167], v[132:135], v[16:19]
    ds_read_b64_tr_b16 v[178:179], v216 offset:16896
    s_waitcnt lgkmcnt(8)
    v_mfma_f32_16x16x32_bf16 v[24:27], v[160:163], v[136:139], v[24:27]
    ds_read_b64_tr_b16 v[180:181], v218 offset:16384
    v_mfma_f32_16x16x32_bf16 v[24:27], v[164:167], v[140:143], v[24:27]
    ds_read_b64_tr_b16 v[182:183], v218 offset:16896
    s_waitcnt lgkmcnt(7)
    v_mfma_f32_16x16x32_bf16 v[32:35], v[160:163], v[144:147], v[32:35]
    s_add_u32 s15, s15, 1
    v_mfma_f32_16x16x32_bf16 v[32:35], v[164:167], v[148:151], v[32:35]
    s_cmp_eq_u32 s15, 3
    s_waitcnt lgkmcnt(4)
    v_mfma_f32_16x16x32_bf16 v[40:43], v[160:163], v[152:155], v[40:43]
    s_cselect_b32 s13, s22, 45056
    v_mfma_f32_16x16x32_bf16 v[40:43], v[164:167], v[156:159], v[40:43]
    s_cselect_b32 s15, 0, s15
    s_waitcnt lgkmcnt(6)
    v_mfma_f32_16x16x32_bf16 v[48:51], v[168:171], v[128:131], v[48:51]
    ds_read_b64_tr_b16 v[184:185], v220 offset:0
    v_mfma_f32_16x16x32_bf16 v[48:51], v[172:175], v[132:135], v[48:51]
    ds_read_b64_tr_b16 v[186:187], v220 offset:256
    v_mfma_f32_16x16x32_bf16 v[56:59], v[168:171], v[136:139], v[56:59]
    ds_read_b64_tr_b16 v[188:189], v222 offset:0
    v_mfma_f32_16x16x32_bf16 v[56:59], v[172:175], v[140:143], v[56:59]
    ds_read_b64_tr_b16 v[190:191], v222 offset:256
    v_mfma_f32_16x16x32_bf16 v[64:67], v[168:171], v[144:147], v[64:67]
    v_add_u32 v216, s13, v216
    v_mfma_f32_16x16x32_bf16 v[64:67], v[172:175], v[148:151], v[64:67]
    v_add_u32 v218, s13, v218
    v_mfma_f32_16x16x32_bf16 v[72:75], v[168:171], v[152:155], v[72:75]
    v_add_u32 v212, s13, v212
    v_mfma_f32_16x16x32_bf16 v[72:75], v[172:175], v[156:159], v[72:75]
    v_add_u32 v213, s13, v213
    s_waitcnt lgkmcnt(4)
    v_mfma_f32_16x16x32_bf16 v[80:83], v[176:179], v[128:131], v[80:83]
    ds_read_b64_tr_b16 v[160:161], v221 offset:0
    v_mfma_f32_16x16x32_bf16 v[80:83], v[180:183], v[132:135], v[80:83]
    ds_read_b64_tr_b16 v[162:163], v221 offset:256
    v_mfma_f32_16x16x32_bf16 v[88:91], v[176:179], v[136:139], v[88:91]
    ds_read_b64_tr_b16 v[164:165], v223 offset:0
    v_mfma_f32_16x16x32_bf16 v[88:91], v[180:183], v[140:143], v[88:91]
    ds_read_b64_tr_b16 v[166:167], v223 offset:256
    v_mfma_f32_16x16x32_bf16 v[96:99], v[176:179], v[144:147], v[96:99]
    v_add_u32 v214, s13, v214
    v_mfma_f32_16x16x32_bf16 v[96:99], v[180:183], v[148:151], v[96:99]
    v_add_u32 v215, s13, v215
    v_mfma_f32_16x16x32_bf16 v[104:107], v[176:179], v[152:155], v[104:107]
    s_add_u32 s14, s14, 1
    v_mfma_f32_16x16x32_bf16 v[104:107], v[180:183], v[156:159], v[104:107]
    s_cmp_lt_u32 s14, 7
    s_waitcnt lgkmcnt(4)
    v_mfma_f32_16x16x32_bf16 v[112:115], v[184:187], v[128:131], v[112:115]
    ds_read_b64_tr_b16 v[168:169], v217 offset:0
    v_mfma_f32_16x16x32_bf16 v[112:115], v[188:191], v[132:135], v[112:115]
    ds_read_b64_tr_b16 v[170:171], v217 offset:512
    v_mfma_f32_16x16x32_bf16 v[120:123], v[184:187], v[136:139], v[120:123]
    ds_read_b64_tr_b16 v[172:173], v219 offset:0
    v_mfma_f32_16x16x32_bf16 v[120:123], v[188:191], v[140:143], v[120:123]
    ds_read_b64_tr_b16 v[174:175], v219 offset:512
    s_waitcnt lgkmcnt(4)
    v_mfma_f32_16x16x32_bf16 v[116:119], v[160:163], v[128:131], v[116:119]
    ds_read_b64_tr_b16 v[176:177], v217 offset:8192
    v_mfma_f32_16x16x32_bf16 v[116:119], v[164:167], v[132:135], v[116:119]
    ds_read_b64_tr_b16 v[178:179], v217 offset:8704
    v_mfma_f32_16x16x32_bf16 v[124:127], v[160:163], v[136:139], v[124:127]
    ds_read_b64_tr_b16 v[180:181], v219 offset:8192
    v_mfma_f32_16x16x32_bf16 v[124:127], v[164:167], v[140:143], v[124:127]
    ds_read_b64_tr_b16 v[182:183], v219 offset:8704
    s_waitcnt lgkmcnt(4)
    v_mfma_f32_16x16x32_bf16 v[20:23], v[168:171], v[128:131], v[20:23]
    ds_read_b64_tr_b16 v[184:185], v217 offset:16384
    v_mfma_f32_16x16x32_bf16 v[20:23], v[172:175], v[132:135], v[20:23]
    ds_read_b64_tr_b16 v[186:187], v217 offset:16896
    v_mfma_f32_16x16x32_bf16 v[28:31], v[168:171], v[136:139], v[28:31]
    ds_read_b64_tr_b16 v[188:189], v219 offset:16384
    v_mfma_f32_16x16x32_bf16 v[28:31], v[172:175], v[140:143], v[28:31]
    ds_read_b64_tr_b16 v[190:191], v219 offset:16896
    v_mfma_f32_16x16x32_bf16 v[36:39], v[168:171], v[144:147], v[36:39]
    v_add_u32 v220, s13, v220
    v_mfma_f32_16x16x32_bf16 v[36:39], v[172:175], v[148:151], v[36:39]
    v_add_u32 v221, s13, v221
    v_mfma_f32_16x16x32_bf16 v[44:47], v[168:171], v[152:155], v[44:47]
    v_add_u32 v222, s13, v222
    v_mfma_f32_16x16x32_bf16 v[44:47], v[172:175], v[156:159], v[44:47]
    v_add_u32 v223, s13, v223
    s_waitcnt lgkmcnt(4)
    v_mfma_f32_16x16x32_bf16 v[52:55], v[176:179], v[128:131], v[52:55]
    v_mfma_f32_16x16x32_bf16 v[52:55], v[180:183], v[132:135], v[52:55]
    s_cbranch_scc1 L_kloop_15
    s_waitcnt lgkmcnt(0)
    s_barrier
    v_mfma_f32_16x16x32_bf16 v[60:63], v[176:179], v[136:139], v[60:63]
    ds_read_b32 v244, v2 offset:512
    ds_read_b32 v245, v2 offset:576
    v_mfma_f32_16x16x32_bf16 v[60:63], v[180:183], v[140:143], v[60:63]
    ds_read_b32 v246, v3 offset:512
    ds_read_b32 v247, v3 offset:576
    v_mfma_f32_16x16x32_bf16 v[68:71], v[176:179], v[144:147], v[68:71]
    ds_read_b32 v240, v2 offset:0
    ds_read_b32 v241, v2 offset:64
    v_mfma_f32_16x16x32_bf16 v[68:71], v[180:183], v[148:151], v[68:71]
    ds_read_b32 v242, v3 offset:0
    ds_read_b32 v243, v3 offset:64
    v_mfma_f32_16x16x32_bf16 v[76:79], v[176:179], v[152:155], v[76:79]
    ds_read_b128 v[160:163], v6 offset:0
    ds_read_b128 v[164:167], v6 offset:64
    v_mfma_f32_16x16x32_bf16 v[76:79], v[180:183], v[156:159], v[76:79]
    ds_read_b128 v[168:171], v6 offset:128
    ds_read_b128 v[172:175], v6 offset:192
    v_mfma_f32_16x16x32_bf16 v[84:87], v[184:187], v[128:131], v[84:87]
    ds_read_b128 v[252:255], v14 offset:384
    v_mfma_f32_16x16x32_bf16 v[84:87], v[188:191], v[132:135], v[84:87]
    ds_read_b128 v[128:131], v4 offset:0
    ds_read_b128 v[132:135], v5 offset:0
    v_mfma_f32_16x16x32_bf16 v[92:95], v[184:187], v[136:139], v[92:95]
    ds_read_b128 v[8:11], v7 offset:384
    v_mfma_f32_16x16x32_bf16 v[92:95], v[188:191], v[140:143], v[92:95]
    ds_read_b128 v[136:139], v4 offset:128
    ds_read_b128 v[140:143], v5 offset:128
    v_mfma_f32_16x16x32_bf16 v[100:103], v[184:187], v[144:147], v[100:103]
    ds_read_b128 v[176:179], v6 offset:256
    v_mfma_f32_16x16x32_bf16 v[100:103], v[188:191], v[148:151], v[100:103]
    ds_read_b128 v[144:147], v4 offset:256
    ds_read_b128 v[148:151], v5 offset:256
    v_mfma_f32_16x16x32_bf16 v[108:111], v[184:187], v[152:155], v[108:111]
    ds_read_b128 v[180:183], v6 offset:320
    v_mfma_f32_16x16x32_bf16 v[108:111], v[188:191], v[156:159], v[108:111]
    ds_read_b128 v[152:155], v4 offset:384
    ds_read_b128 v[156:159], v5 offset:384
    ds_read_b128 v[184:187], v6 offset:384
    ds_read_b128 v[188:191], v6 offset:448
    s_waitcnt lgkmcnt(11)
    v_pk_fma_f32 v[192:193], v[128:129], v[244:245], v[160:161] op_sel:[0,0,0] op_sel_hi:[1,0,1]
    v_pk_fma_f32 v[194:195], v[130:131], v[244:245], v[162:163] op_sel:[0,0,0] op_sel_hi:[1,0,1]
    v_pk_fma_f32 v[196:197], v[132:133], v[244:245], v[164:165] op_sel:[0,0,0] op_sel_hi:[1,0,1]
    v_pk_fma_f32 v[198:199], v[134:135], v[244:245], v[166:167] op_sel:[0,0,0] op_sel_hi:[1,0,1]
    v_pk_fma_f32 v[200:201], v[128:129], v[244:245], v[160:161] op_sel:[0,1,0] op_sel_hi:[1,1,1]
    v_pk_fma_f32 v[202:203], v[130:131], v[244:245], v[162:163] op_sel:[0,1,0] op_sel_hi:[1,1,1]
    v_pk_fma_f32 v[204:205], v[132:133], v[244:245], v[164:165] op_sel:[0,1,0] op_sel_hi:[1,1,1]
    v_pk_fma_f32 v[206:207], v[134:135], v[244:245], v[166:167] op_sel:[0,1,0] op_sel_hi:[1,1,1]
    v_pk_fma_f32 v[192:193], v[16:17], v[240:241], v[192:193] op_sel:[0,0,0] op_sel_hi:[1,0,1]
    v_pk_fma_f32 v[194:195], v[18:19], v[240:241], v[194:195] op_sel:[0,0,0] op_sel_hi:[1,0,1]
    v_pk_fma_f32 v[196:197], v[20:21], v[240:241], v[196:197] op_sel:[0,0,0] op_sel_hi:[1,0,1]
    v_pk_fma_f32 v[198:199], v[22:23], v[240:241], v[198:199] op_sel:[0,0,0] op_sel_hi:[1,0,1]
    v_pk_fma_f32 v[200:201], v[24:25], v[240:241], v[200:201] op_sel:[0,1,0] op_sel_hi:[1,1,1]
    v_pk_fma_f32 v[202:203], v[26:27], v[240:241], v[202:203] op_sel:[0,1,0] op_sel_hi:[1,1,1]
    v_pk_fma_f32 v[204:205], v[28:29], v[240:241], v[204:205] op_sel:[0,1,0] op_sel_hi:[1,1,1]
    v_pk_fma_f32 v[206:207], v[30:31], v[240:241], v[206:207] op_sel:[0,1,0] op_sel_hi:[1,1,1]
    v_exp_f32 v208, v192
    v_exp_f32 v209, v193
    v_exp_f32 v210, v194
    v_exp_f32 v211, v195
    v_exp_f32 v212, v196
    v_exp_f32 v213, v197
    v_exp_f32 v214, v198
    v_exp_f32 v215, v199
    v_exp_f32 v216, v200
    v_exp_f32 v217, v201
    v_exp_f32 v218, v202
    v_exp_f32 v219, v203
    v_exp_f32 v220, v204
    v_exp_f32 v221, v205
    v_exp_f32 v222, v206
    v_exp_f32 v223, v207
    v_pk_add_f32 v[208:209], v[208:209], 1.0 op_sel_hi:[1,0]
    v_pk_add_f32 v[210:211], v[210:211], 1.0 op_sel_hi:[1,0]
    v_pk_add_f32 v[212:213], v[212:213], 1.0 op_sel_hi:[1,0]
    v_pk_add_f32 v[214:215], v[214:215], 1.0 op_sel_hi:[1,0]
    v_pk_add_f32 v[216:217], v[216:217], 1.0 op_sel_hi:[1,0]
    v_pk_add_f32 v[218:219], v[218:219], 1.0 op_sel_hi:[1,0]
    v_pk_add_f32 v[220:221], v[220:221], 1.0 op_sel_hi:[1,0]
    v_pk_add_f32 v[222:223], v[222:223], 1.0 op_sel_hi:[1,0]
    v_pk_fma_f32 v[208:209], v[208:209], v[208:209], 1.0 op_sel_hi:[1,1,0]
    v_pk_fma_f32 v[210:211], v[210:211], v[210:211], 1.0 op_sel_hi:[1,1,0]
    v_pk_fma_f32 v[212:213], v[212:213], v[212:213], 1.0 op_sel_hi:[1,1,0]
    v_pk_fma_f32 v[214:215], v[214:215], v[214:215], 1.0 op_sel_hi:[1,1,0]
    v_pk_fma_f32 v[216:217], v[216:217], v[216:217], 1.0 op_sel_hi:[1,1,0]
    v_pk_fma_f32 v[218:219], v[218:219], v[218:219], 1.0 op_sel_hi:[1,1,0]
    v_pk_fma_f32 v[220:221], v[220:221], v[220:221], 1.0 op_sel_hi:[1,1,0]
    v_pk_fma_f32 v[222:223], v[222:223], v[222:223], 1.0 op_sel_hi:[1,1,0]
    v_rcp_f32 v208, v208
    v_rcp_f32 v209, v209
    v_rcp_f32 v210, v210
    v_rcp_f32 v211, v211
    v_rcp_f32 v212, v212
    v_rcp_f32 v213, v213
    v_rcp_f32 v214, v214
    v_rcp_f32 v215, v215
    v_rcp_f32 v216, v216
    v_rcp_f32 v217, v217
    v_rcp_f32 v218, v218
    v_rcp_f32 v219, v219
    v_rcp_f32 v220, v220
    v_rcp_f32 v221, v221
    v_rcp_f32 v222, v222
    v_rcp_f32 v223, v223
    v_pk_fma_f32 v[208:209], v[208:209], v[232:233], v[232:233] op_sel:[0,0,1] op_sel_hi:[1,0,1]
    v_pk_fma_f32 v[210:211], v[210:211], v[232:233], v[232:233] op_sel:[0,0,1] op_sel_hi:[1,0,1]
    v_pk_fma_f32 v[212:213], v[212:213], v[232:233], v[232:233] op_sel:[0,0,1] op_sel_hi:[1,0,1]
    v_pk_fma_f32 v[214:215], v[214:215], v[232:233], v[232:233] op_sel:[0,0,1] op_sel_hi:[1,0,1]
    v_pk_fma_f32 v[216:217], v[216:217], v[232:233], v[232:233] op_sel:[0,0,1] op_sel_hi:[1,0,1]
    v_pk_fma_f32 v[218:219], v[218:219], v[232:233], v[232:233] op_sel:[0,0,1] op_sel_hi:[1,0,1]
    v_pk_fma_f32 v[220:221], v[220:221], v[232:233], v[232:233] op_sel:[0,0,1] op_sel_hi:[1,0,1]
    v_pk_fma_f32 v[222:223], v[222:223], v[232:233], v[232:233] op_sel:[0,0,1] op_sel_hi:[1,0,1]
    v_pk_mul_f32 v[208:209], v[208:209], v[192:193]
    v_pk_mul_f32 v[210:211], v[210:211], v[194:195]
    v_pk_mul_f32 v[212:213], v[212:213], v[196:197]
    v_pk_mul_f32 v[214:215], v[214:215], v[198:199]
    v_pk_mul_f32 v[216:217], v[216:217], v[200:201]
    v_pk_mul_f32 v[218:219], v[218:219], v[202:203]
    v_pk_mul_f32 v[220:221], v[220:221], v[204:205]
    v_pk_mul_f32 v[222:223], v[222:223], v[206:207]
    v_cvt_pk_bf16_f32 v16, v208, v209
    v_cvt_pk_bf16_f32 v17, v210, v211
    v_cvt_pk_bf16_f32 v18, v212, v213
    v_cvt_pk_bf16_f32 v19, v214, v215
    v_cvt_pk_bf16_f32 v20, v216, v217
    v_cvt_pk_bf16_f32 v21, v218, v219
    v_cvt_pk_bf16_f32 v22, v220, v221
    v_cvt_pk_bf16_f32 v23, v222, v223
    v_pk_fma_f32 v[192:193], v[128:129], v[246:247], v[160:161] op_sel:[0,0,0] op_sel_hi:[1,0,1]
    v_pk_fma_f32 v[194:195], v[130:131], v[246:247], v[162:163] op_sel:[0,0,0] op_sel_hi:[1,0,1]
    v_pk_fma_f32 v[196:197], v[132:133], v[246:247], v[164:165] op_sel:[0,0,0] op_sel_hi:[1,0,1]
    v_pk_fma_f32 v[198:199], v[134:135], v[246:247], v[166:167] op_sel:[0,0,0] op_sel_hi:[1,0,1]
    v_pk_fma_f32 v[200:201], v[128:129], v[246:247], v[160:161] op_sel:[0,1,0] op_sel_hi:[1,1,1]
    v_pk_fma_f32 v[202:203], v[130:131], v[246:247], v[162:163] op_sel:[0,1,0] op_sel_hi:[1,1,1]
    v_pk_fma_f32 v[204:205], v[132:133], v[246:247], v[164:165] op_sel:[0,1,0] op_sel_hi:[1,1,1]
    v_pk_fma_f32 v[206:207], v[134:135], v[246:247], v[166:167] op_sel:[0,1,0] op_sel_hi:[1,1,1]
    v_pk_fma_f32 v[192:193], v[32:33], v[242:243], v[192:193] op_sel:[0,0,0] op_sel_hi:[1,0,1]
    v_pk_fma_f32 v[194:195], v[34:35], v[242:243], v[194:195] op_sel:[0,0,0] op_sel_hi:[1,0,1]
    v_pk_fma_f32 v[196:197], v[36:37], v[242:243], v[196:197] op_sel:[0,0,0] op_sel_hi:[1,0,1]
    v_pk_fma_f32 v[198:199], v[38:39], v[242:243], v[198:199] op_sel:[0,0,0] op_sel_hi:[1,0,1]
    v_pk_fma_f32 v[200:201], v[40:41], v[242:243], v[200:201] op_sel:[0,1,0] op_sel_hi:[1,1,1]
    v_pk_fma_f32 v[202:203], v[42:43], v[242:243], v[202:203] op_sel:[0,1,0] op_sel_hi:[1,1,1]
    v_pk_fma_f32 v[204:205], v[44:45], v[242:243], v[204:205] op_sel:[0,1,0] op_sel_hi:[1,1,1]
    v_pk_fma_f32 v[206:207], v[46:47], v[242:243], v[206:207] op_sel:[0,1,0] op_sel_hi:[1,1,1]
    v_exp_f32 v208, v192
    v_exp_f32 v209, v193
    v_exp_f32 v210, v194
    v_exp_f32 v211, v195
    v_exp_f32 v212, v196
    v_exp_f32 v213, v197
    v_exp_f32 v214, v198
    v_exp_f32 v215, v199
    v_exp_f32 v216, v200
    v_exp_f32 v217, v201
    v_exp_f32 v218, v202
    v_exp_f32 v219, v203
    v_exp_f32 v220, v204
    v_exp_f32 v221, v205
    v_exp_f32 v222, v206
    v_exp_f32 v223, v207
    v_pk_add_f32 v[208:209], v[208:209], 1.0 op_sel_hi:[1,0]
    v_pk_add_f32 v[210:211], v[210:211], 1.0 op_sel_hi:[1,0]
    v_pk_add_f32 v[212:213], v[212:213], 1.0 op_sel_hi:[1,0]
    v_pk_add_f32 v[214:215], v[214:215], 1.0 op_sel_hi:[1,0]
    v_pk_add_f32 v[216:217], v[216:217], 1.0 op_sel_hi:[1,0]
    v_pk_add_f32 v[218:219], v[218:219], 1.0 op_sel_hi:[1,0]
    v_pk_add_f32 v[220:221], v[220:221], 1.0 op_sel_hi:[1,0]
    v_pk_add_f32 v[222:223], v[222:223], 1.0 op_sel_hi:[1,0]
    v_pk_fma_f32 v[208:209], v[208:209], v[208:209], 1.0 op_sel_hi:[1,1,0]
    v_pk_fma_f32 v[210:211], v[210:211], v[210:211], 1.0 op_sel_hi:[1,1,0]
    v_pk_fma_f32 v[212:213], v[212:213], v[212:213], 1.0 op_sel_hi:[1,1,0]
    v_pk_fma_f32 v[214:215], v[214:215], v[214:215], 1.0 op_sel_hi:[1,1,0]
    v_pk_fma_f32 v[216:217], v[216:217], v[216:217], 1.0 op_sel_hi:[1,1,0]
    v_pk_fma_f32 v[218:219], v[218:219], v[218:219], 1.0 op_sel_hi:[1,1,0]
    v_pk_fma_f32 v[220:221], v[220:221], v[220:221], 1.0 op_sel_hi:[1,1,0]
    v_pk_fma_f32 v[222:223], v[222:223], v[222:223], 1.0 op_sel_hi:[1,1,0]
    v_rcp_f32 v208, v208
    v_rcp_f32 v209, v209
    v_rcp_f32 v210, v210
    v_rcp_f32 v211, v211
    v_rcp_f32 v212, v212
    v_rcp_f32 v213, v213
    v_rcp_f32 v214, v214
    v_rcp_f32 v215, v215
    v_rcp_f32 v216, v216
    v_rcp_f32 v217, v217
    v_rcp_f32 v218, v218
    v_rcp_f32 v219, v219
    v_rcp_f32 v220, v220
    v_rcp_f32 v221, v221
    v_rcp_f32 v222, v222
    v_rcp_f32 v223, v223
    v_pk_fma_f32 v[208:209], v[208:209], v[232:233], v[232:233] op_sel:[0,0,1] op_sel_hi:[1,0,1]
    v_pk_fma_f32 v[210:211], v[210:211], v[232:233], v[232:233] op_sel:[0,0,1] op_sel_hi:[1,0,1]
    v_pk_fma_f32 v[212:213], v[212:213], v[232:233], v[232:233] op_sel:[0,0,1] op_sel_hi:[1,0,1]
    v_pk_fma_f32 v[214:215], v[214:215], v[232:233], v[232:233] op_sel:[0,0,1] op_sel_hi:[1,0,1]
    v_pk_fma_f32 v[216:217], v[216:217], v[232:233], v[232:233] op_sel:[0,0,1] op_sel_hi:[1,0,1]
    v_pk_fma_f32 v[218:219], v[218:219], v[232:233], v[232:233] op_sel:[0,0,1] op_sel_hi:[1,0,1]
    v_pk_fma_f32 v[220:221], v[220:221], v[232:233], v[232:233] op_sel:[0,0,1] op_sel_hi:[1,0,1]
    v_pk_fma_f32 v[222:223], v[222:223], v[232:233], v[232:233] op_sel:[0,0,1] op_sel_hi:[1,0,1]
    v_pk_mul_f32 v[208:209], v[208:209], v[192:193]
    v_pk_mul_f32 v[210:211], v[210:211], v[194:195]
    v_pk_mul_f32 v[212:213], v[212:213], v[196:197]
    v_pk_mul_f32 v[214:215], v[214:215], v[198:199]
    v_pk_mul_f32 v[216:217], v[216:217], v[200:201]
    v_pk_mul_f32 v[218:219], v[218:219], v[202:203]
    v_pk_mul_f32 v[220:221], v[220:221], v[204:205]
    v_pk_mul_f32 v[222:223], v[222:223], v[206:207]
    v_cvt_pk_bf16_f32 v32, v208, v209
    v_cvt_pk_bf16_f32 v33, v210, v211
    v_cvt_pk_bf16_f32 v34, v212, v213
    v_cvt_pk_bf16_f32 v35, v214, v215
    v_cvt_pk_bf16_f32 v36, v216, v217
    v_cvt_pk_bf16_f32 v37, v218, v219
    v_cvt_pk_bf16_f32 v38, v220, v221
    v_cvt_pk_bf16_f32 v39, v222, v223
    buffer_store_dwordx4 v[16:19], v225, s[52:55], s76 offen sc1
    buffer_store_dwordx4 v[20:23], v226, s[52:55], s76 offen sc1
    buffer_store_dwordx4 v[32:35], v225, s[52:55], s77 offen sc1
    buffer_store_dwordx4 v[36:39], v226, s[52:55], s77 offen sc1
    s_waitcnt lgkmcnt(0)
    s_nop 0
    v_pk_add_f32 v[152:153], v[152:153], v[8:9]
    v_pk_add_f32 v[156:157], v[156:157], v[252:253]
    v_pk_add_f32 v[154:155], v[154:155], v[10:11]
    v_pk_add_f32 v[158:159], v[158:159], v[254:255]
    v_pk_fma_f32 v[192:193], v[136:137], v[244:245], v[168:169] op_sel:[0,0,0] op_sel_hi:[1,0,1]
    v_pk_fma_f32 v[194:195], v[138:139], v[244:245], v[170:171] op_sel:[0,0,0] op_sel_hi:[1,0,1]
    v_pk_fma_f32 v[196:197], v[140:141], v[244:245], v[172:173] op_sel:[0,0,0] op_sel_hi:[1,0,1]
    v_pk_fma_f32 v[198:199], v[142:143], v[244:245], v[174:175] op_sel:[0,0,0] op_sel_hi:[1,0,1]
    v_pk_fma_f32 v[200:201], v[136:137], v[244:245], v[168:169] op_sel:[0,1,0] op_sel_hi:[1,1,1]
    v_pk_fma_f32 v[202:203], v[138:139], v[244:245], v[170:171] op_sel:[0,1,0] op_sel_hi:[1,1,1]
    v_pk_fma_f32 v[204:205], v[140:141], v[244:245], v[172:173] op_sel:[0,1,0] op_sel_hi:[1,1,1]
    v_pk_fma_f32 v[206:207], v[142:143], v[244:245], v[174:175] op_sel:[0,1,0] op_sel_hi:[1,1,1]
    v_pk_fma_f32 v[192:193], v[48:49], v[240:241], v[192:193] op_sel:[0,0,0] op_sel_hi:[1,0,1]
    v_pk_fma_f32 v[194:195], v[50:51], v[240:241], v[194:195] op_sel:[0,0,0] op_sel_hi:[1,0,1]
    v_pk_fma_f32 v[196:197], v[52:53], v[240:241], v[196:197] op_sel:[0,0,0] op_sel_hi:[1,0,1]
    v_pk_fma_f32 v[198:199], v[54:55], v[240:241], v[198:199] op_sel:[0,0,0] op_sel_hi:[1,0,1]
    v_pk_fma_f32 v[200:201], v[56:57], v[240:241], v[200:201] op_sel:[0,1,0] op_sel_hi:[1,1,1]
    v_pk_fma_f32 v[202:203], v[58:59], v[240:241], v[202:203] op_sel:[0,1,0] op_sel_hi:[1,1,1]
    v_pk_fma_f32 v[204:205], v[60:61], v[240:241], v[204:205] op_sel:[0,1,0] op_sel_hi:[1,1,1]
    v_pk_fma_f32 v[206:207], v[62:63], v[240:241], v[206:207] op_sel:[0,1,0] op_sel_hi:[1,1,1]
    v_exp_f32 v208, v192
    v_exp_f32 v209, v193
    v_exp_f32 v210, v194
    v_exp_f32 v211, v195
    v_exp_f32 v212, v196
    v_exp_f32 v213, v197
    v_exp_f32 v214, v198
    v_exp_f32 v215, v199
    v_exp_f32 v216, v200
    v_exp_f32 v217, v201
    v_exp_f32 v218, v202
    v_exp_f32 v219, v203
    v_exp_f32 v220, v204
    v_exp_f32 v221, v205
    v_exp_f32 v222, v206
    v_exp_f32 v223, v207
    v_pk_add_f32 v[208:209], v[208:209], 1.0 op_sel_hi:[1,0]
    v_pk_add_f32 v[210:211], v[210:211], 1.0 op_sel_hi:[1,0]
    v_pk_add_f32 v[212:213], v[212:213], 1.0 op_sel_hi:[1,0]
    v_pk_add_f32 v[214:215], v[214:215], 1.0 op_sel_hi:[1,0]
    v_pk_add_f32 v[216:217], v[216:217], 1.0 op_sel_hi:[1,0]
    v_pk_add_f32 v[218:219], v[218:219], 1.0 op_sel_hi:[1,0]
    v_pk_add_f32 v[220:221], v[220:221], 1.0 op_sel_hi:[1,0]
    v_pk_add_f32 v[222:223], v[222:223], 1.0 op_sel_hi:[1,0]
    v_pk_fma_f32 v[208:209], v[208:209], v[208:209], 1.0 op_sel_hi:[1,1,0]
    v_pk_fma_f32 v[210:211], v[210:211], v[210:211], 1.0 op_sel_hi:[1,1,0]
    v_pk_fma_f32 v[212:213], v[212:213], v[212:213], 1.0 op_sel_hi:[1,1,0]
    v_pk_fma_f32 v[214:215], v[214:215], v[214:215], 1.0 op_sel_hi:[1,1,0]
    v_pk_fma_f32 v[216:217], v[216:217], v[216:217], 1.0 op_sel_hi:[1,1,0]
    v_pk_fma_f32 v[218:219], v[218:219], v[218:219], 1.0 op_sel_hi:[1,1,0]
    v_pk_fma_f32 v[220:221], v[220:221], v[220:221], 1.0 op_sel_hi:[1,1,0]
    v_pk_fma_f32 v[222:223], v[222:223], v[222:223], 1.0 op_sel_hi:[1,1,0]
    v_rcp_f32 v208, v208
    v_rcp_f32 v209, v209
    v_rcp_f32 v210, v210
    v_rcp_f32 v211, v211
    v_rcp_f32 v212, v212
    v_rcp_f32 v213, v213
    v_rcp_f32 v214, v214
    v_rcp_f32 v215, v215
    v_rcp_f32 v216, v216
    v_rcp_f32 v217, v217
    v_rcp_f32 v218, v218
    v_rcp_f32 v219, v219
    v_rcp_f32 v220, v220
    v_rcp_f32 v221, v221
    v_rcp_f32 v222, v222
    v_rcp_f32 v223, v223
    v_pk_fma_f32 v[208:209], v[208:209], v[232:233], v[232:233] op_sel:[0,0,1] op_sel_hi:[1,0,1]
    v_pk_fma_f32 v[210:211], v[210:211], v[232:233], v[232:233] op_sel:[0,0,1] op_sel_hi:[1,0,1]
    v_pk_fma_f32 v[212:213], v[212:213], v[232:233], v[232:233] op_sel:[0,0,1] op_sel_hi:[1,0,1]
    v_pk_fma_f32 v[214:215], v[214:215], v[232:233], v[232:233] op_sel:[0,0,1] op_sel_hi:[1,0,1]
    v_pk_fma_f32 v[216:217], v[216:217], v[232:233], v[232:233] op_sel:[0,0,1] op_sel_hi:[1,0,1]
    v_pk_fma_f32 v[218:219], v[218:219], v[232:233], v[232:233] op_sel:[0,0,1] op_sel_hi:[1,0,1]
    v_pk_fma_f32 v[220:221], v[220:221], v[232:233], v[232:233] op_sel:[0,0,1] op_sel_hi:[1,0,1]
    v_pk_fma_f32 v[222:223], v[222:223], v[232:233], v[232:233] op_sel:[0,0,1] op_sel_hi:[1,0,1]
    v_pk_mul_f32 v[208:209], v[208:209], v[192:193]
    v_pk_mul_f32 v[210:211], v[210:211], v[194:195]
    v_pk_mul_f32 v[212:213], v[212:213], v[196:197]
    v_pk_mul_f32 v[214:215], v[214:215], v[198:199]
    v_pk_mul_f32 v[216:217], v[216:217], v[200:201]
    v_pk_mul_f32 v[218:219], v[218:219], v[202:203]
    v_pk_mul_f32 v[220:221], v[220:221], v[204:205]
    v_pk_mul_f32 v[222:223], v[222:223], v[206:207]
    v_cvt_pk_bf16_f32 v48, v208, v209
    v_cvt_pk_bf16_f32 v49, v210, v211
    v_cvt_pk_bf16_f32 v50, v212, v213
    v_cvt_pk_bf16_f32 v51, v214, v215
    v_cvt_pk_bf16_f32 v52, v216, v217
    v_cvt_pk_bf16_f32 v53, v218, v219
    v_cvt_pk_bf16_f32 v54, v220, v221
    v_cvt_pk_bf16_f32 v55, v222, v223
    v_pk_fma_f32 v[192:193], v[136:137], v[246:247], v[168:169] op_sel:[0,0,0] op_sel_hi:[1,0,1]
    v_pk_fma_f32 v[194:195], v[138:139], v[246:247], v[170:171] op_sel:[0,0,0] op_sel_hi:[1,0,1]
    v_pk_fma_f32 v[196:197], v[140:141], v[246:247], v[172:173] op_sel:[0,0,0] op_sel_hi:[1,0,1]
    v_pk_fma_f32 v[198:199], v[142:143], v[246:247], v[174:175] op_sel:[0,0,0] op_sel_hi:[1,0,1]
    v_pk_fma_f32 v[200:201], v[136:137], v[246:247], v[168:169] op_sel:[0,1,0] op_sel_hi:[1,1,1]
    v_pk_fma_f32 v[202:203], v[138:139], v[246:247], v[170:171] op_sel:[0,1,0] op_sel_hi:[1,1,1]
    v_pk_fma_f32 v[204:205], v[140:141], v[246:247], v[172:173] op_sel:[0,1,0] op_sel_hi:[1,1,1]
    v_pk_fma_f32 v[206:207], v[142:143], v[246:247], v[174:175] op_sel:[0,1,0] op_sel_hi:[1,1,1]
    v_pk_fma_f32 v[192:193], v[64:65], v[242:243], v[192:193] op_sel:[0,0,0] op_sel_hi:[1,0,1]
    v_pk_fma_f32 v[194:195], v[66:67], v[242:243], v[194:195] op_sel:[0,0,0] op_sel_hi:[1,0,1]
    v_pk_fma_f32 v[196:197], v[68:69], v[242:243], v[196:197] op_sel:[0,0,0] op_sel_hi:[1,0,1]
    v_pk_fma_f32 v[198:199], v[70:71], v[242:243], v[198:199] op_sel:[0,0,0] op_sel_hi:[1,0,1]
    v_pk_fma_f32 v[200:201], v[72:73], v[242:243], v[200:201] op_sel:[0,1,0] op_sel_hi:[1,1,1]
    v_pk_fma_f32 v[202:203], v[74:75], v[242:243], v[202:203] op_sel:[0,1,0] op_sel_hi:[1,1,1]
    v_pk_fma_f32 v[204:205], v[76:77], v[242:243], v[204:205] op_sel:[0,1,0] op_sel_hi:[1,1,1]
    v_pk_fma_f32 v[206:207], v[78:79], v[242:243], v[206:207] op_sel:[0,1,0] op_sel_hi:[1,1,1]
    v_exp_f32 v208, v192
    v_exp_f32 v209, v193
    v_exp_f32 v210, v194
    v_exp_f32 v211, v195
    v_exp_f32 v212, v196
    v_exp_f32 v213, v197
    v_exp_f32 v214, v198
    v_exp_f32 v215, v199
    v_exp_f32 v216, v200
    v_exp_f32 v217, v201
    v_exp_f32 v218, v202
    v_exp_f32 v219, v203
    v_exp_f32 v220, v204
    v_exp_f32 v221, v205
    v_exp_f32 v222, v206
    v_exp_f32 v223, v207
    v_pk_add_f32 v[208:209], v[208:209], 1.0 op_sel_hi:[1,0]
    v_pk_add_f32 v[210:211], v[210:211], 1.0 op_sel_hi:[1,0]
    v_pk_add_f32 v[212:213], v[212:213], 1.0 op_sel_hi:[1,0]
    v_pk_add_f32 v[214:215], v[214:215], 1.0 op_sel_hi:[1,0]
    v_pk_add_f32 v[216:217], v[216:217], 1.0 op_sel_hi:[1,0]
    v_pk_add_f32 v[218:219], v[218:219], 1.0 op_sel_hi:[1,0]
    v_pk_add_f32 v[220:221], v[220:221], 1.0 op_sel_hi:[1,0]
    v_pk_add_f32 v[222:223], v[222:223], 1.0 op_sel_hi:[1,0]
    v_pk_fma_f32 v[208:209], v[208:209], v[208:209], 1.0 op_sel_hi:[1,1,0]
    v_pk_fma_f32 v[210:211], v[210:211], v[210:211], 1.0 op_sel_hi:[1,1,0]
    v_pk_fma_f32 v[212:213], v[212:213], v[212:213], 1.0 op_sel_hi:[1,1,0]
    v_pk_fma_f32 v[214:215], v[214:215], v[214:215], 1.0 op_sel_hi:[1,1,0]
    v_pk_fma_f32 v[216:217], v[216:217], v[216:217], 1.0 op_sel_hi:[1,1,0]
    v_pk_fma_f32 v[218:219], v[218:219], v[218:219], 1.0 op_sel_hi:[1,1,0]
    v_pk_fma_f32 v[220:221], v[220:221], v[220:221], 1.0 op_sel_hi:[1,1,0]
    v_pk_fma_f32 v[222:223], v[222:223], v[222:223], 1.0 op_sel_hi:[1,1,0]
    v_rcp_f32 v208, v208
    v_rcp_f32 v209, v209
    v_rcp_f32 v210, v210
    v_rcp_f32 v211, v211
    v_rcp_f32 v212, v212
    v_rcp_f32 v213, v213
    v_rcp_f32 v214, v214
    v_rcp_f32 v215, v215
    v_rcp_f32 v216, v216
    v_rcp_f32 v217, v217
    v_rcp_f32 v218, v218
    v_rcp_f32 v219, v219
    v_rcp_f32 v220, v220
    v_rcp_f32 v221, v221
    v_rcp_f32 v222, v222
    v_rcp_f32 v223, v223
    v_pk_fma_f32 v[208:209], v[208:209], v[232:233], v[232:233] op_sel:[0,0,1] op_sel_hi:[1,0,1]
    v_pk_fma_f32 v[210:211], v[210:211], v[232:233], v[232:233] op_sel:[0,0,1] op_sel_hi:[1,0,1]
    v_pk_fma_f32 v[212:213], v[212:213], v[232:233], v[232:233] op_sel:[0,0,1] op_sel_hi:[1,0,1]
    v_pk_fma_f32 v[214:215], v[214:215], v[232:233], v[232:233] op_sel:[0,0,1] op_sel_hi:[1,0,1]
    v_pk_fma_f32 v[216:217], v[216:217], v[232:233], v[232:233] op_sel:[0,0,1] op_sel_hi:[1,0,1]
    v_pk_fma_f32 v[218:219], v[218:219], v[232:233], v[232:233] op_sel:[0,0,1] op_sel_hi:[1,0,1]
    v_pk_fma_f32 v[220:221], v[220:221], v[232:233], v[232:233] op_sel:[0,0,1] op_sel_hi:[1,0,1]
    v_pk_fma_f32 v[222:223], v[222:223], v[232:233], v[232:233] op_sel:[0,0,1] op_sel_hi:[1,0,1]
    v_pk_mul_f32 v[208:209], v[208:209], v[192:193]
    v_pk_mul_f32 v[210:211], v[210:211], v[194:195]
    v_pk_mul_f32 v[212:213], v[212:213], v[196:197]
    v_pk_mul_f32 v[214:215], v[214:215], v[198:199]
    v_pk_mul_f32 v[216:217], v[216:217], v[200:201]
    v_pk_mul_f32 v[218:219], v[218:219], v[202:203]
    v_pk_mul_f32 v[220:221], v[220:221], v[204:205]
    v_pk_mul_f32 v[222:223], v[222:223], v[206:207]
    v_cvt_pk_bf16_f32 v64, v208, v209
    v_cvt_pk_bf16_f32 v65, v210, v211
    v_cvt_pk_bf16_f32 v66, v212, v213
    v_cvt_pk_bf16_f32 v67, v214, v215
    v_cvt_pk_bf16_f32 v68, v216, v217
    v_cvt_pk_bf16_f32 v69, v218, v219
    v_cvt_pk_bf16_f32 v70, v220, v221
    s_waitcnt vmcnt(0)
    s_nop 0
    s_atomic_swap s68, s[66:67], 0
    buffer_load_dwordx4 v[40:43], v1, s[36:39], s18 offen offset:0
    buffer_load_dwordx4 v[44:47], v1, s[36:39], s18 offen offset:64
    v_cvt_pk_bf16_f32 v71, v222, v223
    buffer_store_dwordx4 v[48:51], v225, s[52:55], s70 offen sc1
    buffer_store_dwordx4 v[52:55], v226, s[52:55], s70 offen sc1
    buffer_store_dwordx4 v[64:67], v225, s[52:55], s71 offen sc1
    buffer_store_dwordx4 v[68:71], v226, s[52:55], s71 offen sc1
    v_pk_fma_f32 v[192:193], v[144:145], v[244:245], v[176:177] op_sel:[0,0,0] op_sel_hi:[1,0,1]
    v_pk_fma_f32 v[194:195], v[146:147], v[244:245], v[178:179] op_sel:[0,0,0] op_sel_hi:[1,0,1]
    v_pk_fma_f32 v[196:197], v[148:149], v[244:245], v[180:181] op_sel:[0,0,0] op_sel_hi:[1,0,1]
    v_pk_fma_f32 v[198:199], v[150:151], v[244:245], v[182:183] op_sel:[0,0,0] op_sel_hi:[1,0,1]
    v_pk_fma_f32 v[200:201], v[144:145], v[244:245], v[176:177] op_sel:[0,1,0] op_sel_hi:[1,1,1]
    v_pk_fma_f32 v[202:203], v[146:147], v[244:245], v[178:179] op_sel:[0,1,0] op_sel_hi:[1,1,1]
    v_pk_fma_f32 v[204:205], v[148:149], v[244:245], v[180:181] op_sel:[0,1,0] op_sel_hi:[1,1,1]
    v_pk_fma_f32 v[206:207], v[150:151], v[244:245], v[182:183] op_sel:[0,1,0] op_sel_hi:[1,1,1]
    v_pk_fma_f32 v[192:193], v[80:81], v[240:241], v[192:193] op_sel:[0,0,0] op_sel_hi:[1,0,1]
    v_pk_fma_f32 v[194:195], v[82:83], v[240:241], v[194:195] op_sel:[0,0,0] op_sel_hi:[1,0,1]
    v_pk_fma_f32 v[196:197], v[84:85], v[240:241], v[196:197] op_sel:[0,0,0] op_sel_hi:[1,0,1]
    v_pk_fma_f32 v[198:199], v[86:87], v[240:241], v[198:199] op_sel:[0,0,0] op_sel_hi:[1,0,1]
    v_pk_fma_f32 v[200:201], v[88:89], v[240:241], v[200:201] op_sel:[0,1,0] op_sel_hi:[1,1,1]
    v_pk_fma_f32 v[202:203], v[90:91], v[240:241], v[202:203] op_sel:[0,1,0] op_sel_hi:[1,1,1]
    v_pk_fma_f32 v[204:205], v[92:93], v[240:241], v[204:205] op_sel:[0,1,0] op_sel_hi:[1,1,1]
    v_pk_fma_f32 v[206:207], v[94:95], v[240:241], v[206:207] op_sel:[0,1,0] op_sel_hi:[1,1,1]
    v_exp_f32 v208, v192
    v_exp_f32 v209, v193
    v_exp_f32 v210, v194
    v_exp_f32 v211, v195
    v_exp_f32 v212, v196
    v_exp_f32 v213, v197
    v_exp_f32 v214, v198
    v_exp_f32 v215, v199
    v_exp_f32 v216, v200
    v_exp_f32 v217, v201
    v_exp_f32 v218, v202
    v_exp_f32 v219, v203
    v_exp_f32 v220, v204
    v_exp_f32 v221, v205
    v_exp_f32 v222, v206
    v_exp_f32 v223, v207
    v_pk_add_f32 v[208:209], v[208:209], 1.0 op_sel_hi:[1,0]
    v_pk_add_f32 v[210:211], v[210:211], 1.0 op_sel_hi:[1,0]
    v_pk_add_f32 v[212:213], v[212:213], 1.0 op_sel_hi:[1,0]
    v_pk_add_f32 v[214:215], v[214:215], 1.0 op_sel_hi:[1,0]
    v_pk_add_f32 v[216:217], v[216:217], 1.0 op_sel_hi:[1,0]
    v_pk_add_f32 v[218:219], v[218:219], 1.0 op_sel_hi:[1,0]
    v_pk_add_f32 v[220:221], v[220:221], 1.0 op_sel_hi:[1,0]
    v_pk_add_f32 v[222:223], v[222:223], 1.0 op_sel_hi:[1,0]
    v_pk_fma_f32 v[208:209], v[208:209], v[208:209], 1.0 op_sel_hi:[1,1,0]
    v_pk_fma_f32 v[210:211], v[210:211], v[210:211], 1.0 op_sel_hi:[1,1,0]
    v_pk_fma_f32 v[212:213], v[212:213], v[212:213], 1.0 op_sel_hi:[1,1,0]
    v_pk_fma_f32 v[214:215], v[214:215], v[214:215], 1.0 op_sel_hi:[1,1,0]
    v_pk_fma_f32 v[216:217], v[216:217], v[216:217], 1.0 op_sel_hi:[1,1,0]
    v_pk_fma_f32 v[218:219], v[218:219], v[218:219], 1.0 op_sel_hi:[1,1,0]
    v_pk_fma_f32 v[220:221], v[220:221], v[220:221], 1.0 op_sel_hi:[1,1,0]
    v_pk_fma_f32 v[222:223], v[222:223], v[222:223], 1.0 op_sel_hi:[1,1,0]
    v_rcp_f32 v208, v208
    v_rcp_f32 v209, v209
    v_rcp_f32 v210, v210
    v_rcp_f32 v211, v211
    v_rcp_f32 v212, v212
    v_rcp_f32 v213, v213
    v_rcp_f32 v214, v214
    v_rcp_f32 v215, v215
    v_rcp_f32 v216, v216
    v_rcp_f32 v217, v217
    v_rcp_f32 v218, v218
    v_rcp_f32 v219, v219
    v_rcp_f32 v220, v220
    v_rcp_f32 v221, v221
    v_rcp_f32 v222, v222
    v_rcp_f32 v223, v223
    v_pk_fma_f32 v[208:209], v[208:209], v[232:233], v[232:233] op_sel:[0,0,1] op_sel_hi:[1,0,1]
    v_pk_fma_f32 v[210:211], v[210:211], v[232:233], v[232:233] op_sel:[0,0,1] op_sel_hi:[1,0,1]
    v_pk_fma_f32 v[212:213], v[212:213], v[232:233], v[232:233] op_sel:[0,0,1] op_sel_hi:[1,0,1]
    v_pk_fma_f32 v[214:215], v[214:215], v[232:233], v[232:233] op_sel:[0,0,1] op_sel_hi:[1,0,1]
    v_pk_fma_f32 v[216:217], v[216:217], v[232:233], v[232:233] op_sel:[0,0,1] op_sel_hi:[1,0,1]
    v_pk_fma_f32 v[218:219], v[218:219], v[232:233], v[232:233] op_sel:[0,0,1] op_sel_hi:[1,0,1]
    v_pk_fma_f32 v[220:221], v[220:221], v[232:233], v[232:233] op_sel:[0,0,1] op_sel_hi:[1,0,1]
    v_pk_fma_f32 v[222:223], v[222:223], v[232:233], v[232:233] op_sel:[0,0,1] op_sel_hi:[1,0,1]
    v_pk_mul_f32 v[208:209], v[208:209], v[192:193]
    v_pk_mul_f32 v[210:211], v[210:211], v[194:195]
    v_pk_mul_f32 v[212:213], v[212:213], v[196:197]
    v_pk_mul_f32 v[214:215], v[214:215], v[198:199]
    v_pk_mul_f32 v[216:217], v[216:217], v[200:201]
    v_pk_mul_f32 v[218:219], v[218:219], v[202:203]
    v_pk_mul_f32 v[220:221], v[220:221], v[204:205]
    v_pk_mul_f32 v[222:223], v[222:223], v[206:207]
    v_cvt_pk_bf16_f32 v80, v208, v209
    v_cvt_pk_bf16_f32 v81, v210, v211
    v_cvt_pk_bf16_f32 v82, v212, v213
    v_cvt_pk_bf16_f32 v83, v214, v215
    v_cvt_pk_bf16_f32 v84, v216, v217
    v_cvt_pk_bf16_f32 v85, v218, v219
    v_cvt_pk_bf16_f32 v86, v220, v221
    v_cvt_pk_bf16_f32 v87, v222, v223
    v_pk_fma_f32 v[192:193], v[144:145], v[246:247], v[176:177] op_sel:[0,0,0] op_sel_hi:[1,0,1]
    v_pk_fma_f32 v[194:195], v[146:147], v[246:247], v[178:179] op_sel:[0,0,0] op_sel_hi:[1,0,1]
    v_pk_fma_f32 v[196:197], v[148:149], v[246:247], v[180:181] op_sel:[0,0,0] op_sel_hi:[1,0,1]
    v_pk_fma_f32 v[198:199], v[150:151], v[246:247], v[182:183] op_sel:[0,0,0] op_sel_hi:[1,0,1]
    v_pk_fma_f32 v[200:201], v[144:145], v[246:247], v[176:177] op_sel:[0,1,0] op_sel_hi:[1,1,1]
    v_pk_fma_f32 v[202:203], v[146:147], v[246:247], v[178:179] op_sel:[0,1,0] op_sel_hi:[1,1,1]
    v_pk_fma_f32 v[204:205], v[148:149], v[246:247], v[180:181] op_sel:[0,1,0] op_sel_hi:[1,1,1]
    v_pk_fma_f32 v[206:207], v[150:151], v[246:247], v[182:183] op_sel:[0,1,0] op_sel_hi:[1,1,1]
    v_pk_fma_f32 v[192:193], v[96:97], v[242:243], v[192:193] op_sel:[0,0,0] op_sel_hi:[1,0,1]
    v_pk_fma_f32 v[194:195], v[98:99], v[242:243], v[194:195] op_sel:[0,0,0] op_sel_hi:[1,0,1]
    v_pk_fma_f32 v[196:197], v[100:101], v[242:243], v[196:197] op_sel:[0,0,0] op_sel_hi:[1,0,1]
    v_pk_fma_f32 v[198:199], v[102:103], v[242:243], v[198:199] op_sel:[0,0,0] op_sel_hi:[1,0,1]
    v_pk_fma_f32 v[200:201], v[104:105], v[242:243], v[200:201] op_sel:[0,1,0] op_sel_hi:[1,1,1]
    v_pk_fma_f32 v[202:203], v[106:107], v[242:243], v[202:203] op_sel:[0,1,0] op_sel_hi:[1,1,1]
    v_pk_fma_f32 v[204:205], v[108:109], v[242:243], v[204:205] op_sel:[0,1,0] op_sel_hi:[1,1,1]
    v_pk_fma_f32 v[206:207], v[110:111], v[242:243], v[206:207] op_sel:[0,1,0] op_sel_hi:[1,1,1]
    v_exp_f32 v208, v192
    v_exp_f32 v209, v193
    v_exp_f32 v210, v194
    v_exp_f32 v211, v195
    v_exp_f32 v212, v196
    v_exp_f32 v213, v197
    v_exp_f32 v214, v198
    v_exp_f32 v215, v199
    v_exp_f32 v216, v200
    v_exp_f32 v217, v201
    v_exp_f32 v218, v202
    v_exp_f32 v219, v203
    v_exp_f32 v220, v204
    v_exp_f32 v221, v205
    v_mov_b32 v2, s64
    ds_read_b128 v[4:7], v2 offset:16
    v_exp_f32_e64 v222, v206
    v_exp_f32 v223, v207
    v_pk_add_f32 v[208:209], v[208:209], 1.0 op_sel_hi:[1,0]
    v_pk_add_f32 v[210:211], v[210:211], 1.0 op_sel_hi:[1,0]
    v_pk_add_f32 v[212:213], v[212:213], 1.0 op_sel_hi:[1,0]
    v_pk_add_f32 v[214:215], v[214:215], 1.0 op_sel_hi:[1,0]
    v_pk_add_f32 v[216:217], v[216:217], 1.0 op_sel_hi:[1,0]
    v_pk_add_f32 v[218:219], v[218:219], 1.0 op_sel_hi:[1,0]
    v_pk_add_f32 v[220:221], v[220:221], 1.0 op_sel_hi:[1,0]
    v_pk_add_f32 v[222:223], v[222:223], 1.0 op_sel_hi:[1,0]
    v_pk_fma_f32 v[208:209], v[208:209], v[208:209], 1.0 op_sel_hi:[1,1,0]
    v_pk_fma_f32 v[210:211], v[210:211], v[210:211], 1.0 op_sel_hi:[1,1,0]
    v_pk_fma_f32 v[212:213], v[212:213], v[212:213], 1.0 op_sel_hi:[1,1,0]
    v_pk_fma_f32 v[214:215], v[214:215], v[214:215], 1.0 op_sel_hi:[1,1,0]
    v_pk_fma_f32 v[216:217], v[216:217], v[216:217], 1.0 op_sel_hi:[1,1,0]
    v_pk_fma_f32 v[218:219], v[218:219], v[218:219], 1.0 op_sel_hi:[1,1,0]
    v_pk_fma_f32 v[220:221], v[220:221], v[220:221], 1.0 op_sel_hi:[1,1,0]
    v_pk_fma_f32 v[222:223], v[222:223], v[222:223], 1.0 op_sel_hi:[1,1,0]
    v_rcp_f32 v208, v208
    v_rcp_f32 v209, v209
    v_rcp_f32 v210, v210
    v_rcp_f32 v211, v211
    v_rcp_f32 v212, v212
    v_rcp_f32 v213, v213
    v_rcp_f32 v214, v214
    v_rcp_f32 v215, v215
    v_rcp_f32 v216, v216
    v_rcp_f32 v217, v217
    v_rcp_f32 v218, v218
    v_rcp_f32 v219, v219
    s_waitcnt vmcnt(0) lgkmcnt(0)
    s_atomic_swap s68, s[66:67], 1024
    v_and_b32 v4, v4, v5
    v_and_b32 v6, v6, v7
    v_and_b32 v4, v4, v6
    s_nop 0
    v_readfirstlane_b32 s75, v4
    s_nop 0
    s_cmp_eq_u32 s75, 0
    s_cbranch_scc1 L_landm_18
L_landd_17:
    v_rcp_f32 v220, v220
    v_rcp_f32 v221, v221
    s_load_dwordx4 s[44:47], s[40:41], 0 glc
    v_rcp_f32_e64 v222, v222
    v_rcp_f32 v223, v223
    v_pk_fma_f32 v[208:209], v[208:209], v[232:233], v[232:233] op_sel:[0,0,1] op_sel_hi:[1,0,1]
    v_pk_fma_f32 v[210:211], v[210:211], v[232:233], v[232:233] op_sel:[0,0,1] op_sel_hi:[1,0,1]
    v_pk_fma_f32 v[212:213], v[212:213], v[232:233], v[232:233] op_sel:[0,0,1] op_sel_hi:[1,0,1]
    v_pk_fma_f32 v[214:215], v[214:215], v[232:233], v[232:233] op_sel:[0,0,1] op_sel_hi:[1,0,1]
    v_pk_fma_f32 v[216:217], v[216:217], v[232:233], v[232:233] op_sel:[0,0,1] op_sel_hi:[1,0,1]
    v_pk_fma_f32 v[218:219], v[218:219], v[232:233], v[232:233] op_sel:[0,0,1] op_sel_hi:[1,0,1]
    v_pk_fma_f32 v[220:221], v[220:221], v[232:233], v[232:233] op_sel:[0,0,1] op_sel_hi:[1,0,1]
    v_pk_fma_f32 v[222:223], v[222:223], v[232:233], v[232:233] op_sel:[0,0,1] op_sel_hi:[1,0,1]
    v_pk_mul_f32 v[208:209], v[208:209], v[192:193]
    v_pk_mul_f32 v[210:211], v[210:211], v[194:195]
    v_pk_mul_f32 v[212:213], v[212:213], v[196:197]
    v_pk_mul_f32 v[214:215], v[214:215], v[198:199]
    v_pk_mul_f32 v[216:217], v[216:217], v[200:201]
    v_pk_mul_f32 v[218:219], v[218:219], v[202:203]
    v_pk_mul_f32 v[220:221], v[220:221], v[204:205]
    v_pk_mul_f32 v[222:223], v[222:223], v[206:207]
    v_cvt_pk_bf16_f32 v96, v208, v209
    v_cvt_pk_bf16_f32 v97, v210, v211
    v_cvt_pk_bf16_f32 v98, v212, v213
    v_cvt_pk_bf16_f32 v99, v214, v215
    v_cvt_pk_bf16_f32 v100, v216, v217
    v_cvt_pk_bf16_f32 v101, v218, v219
    v_cvt_pk_bf16_f32 v102, v220, v221
    v_cvt_pk_bf16_f32 v103, v222, v223
    buffer_store_dwordx4 v[80:83], v225, s[52:55], s72 offen sc1
    buffer_store_dwordx4 v[84:87], v226, s[52:55], s72 offen sc1
    buffer_store_dwordx4 v[96:99], v225, s[52:55], s73 offen sc1
    buffer_store_dwordx4 v[100:103], v226, s[52:55], s73 offen sc1
    v_pk_fma_f32 v[192:193], v[152:153], v[244:245], v[184:185] op_sel:[0,0,0] op_sel_hi:[1,0,1]
    v_pk_fma_f32 v[194:195], v[154:155], v[244:245], v[186:187] op_sel:[0,0,0] op_sel_hi:[1,0,1]
    v_pk_fma_f32 v[196:197], v[156:157], v[244:245], v[188:189] op_sel:[0,0,0] op_sel_hi:[1,0,1]
    v_pk_fma_f32 v[198:199], v[158:159], v[244:245], v[190:191] op_sel:[0,0,0] op_sel_hi:[1,0,1]
    v_pk_fma_f32 v[200:201], v[152:153], v[244:245], v[184:185] op_sel:[0,1,0] op_sel_hi:[1,1,1]
    v_pk_fma_f32 v[202:203], v[154:155], v[244:245], v[186:187] op_sel:[0,1,0] op_sel_hi:[1,1,1]
    v_pk_fma_f32 v[204:205], v[156:157], v[244:245], v[188:189] op_sel:[0,1,0] op_sel_hi:[1,1,1]
    v_pk_fma_f32 v[206:207], v[158:159], v[244:245], v[190:191] op_sel:[0,1,0] op_sel_hi:[1,1,1]
    v_pk_fma_f32 v[192:193], v[112:113], v[240:241], v[192:193] op_sel:[0,0,0] op_sel_hi:[1,0,1]
    v_pk_fma_f32 v[194:195], v[114:115], v[240:241], v[194:195] op_sel:[0,0,0] op_sel_hi:[1,0,1]
    v_pk_fma_f32 v[196:197], v[116:117], v[240:241], v[196:197] op_sel:[0,0,0] op_sel_hi:[1,0,1]
    v_pk_fma_f32 v[198:199], v[118:119], v[240:241], v[198:199] op_sel:[0,0,0] op_sel_hi:[1,0,1]
    v_pk_fma_f32 v[200:201], v[120:121], v[240:241], v[200:201] op_sel:[0,1,0] op_sel_hi:[1,1,1]
    v_pk_fma_f32 v[202:203], v[122:123], v[240:241], v[202:203] op_sel:[0,1,0] op_sel_hi:[1,1,1]
    v_pk_fma_f32 v[204:205], v[124:125], v[240:241], v[204:205] op_sel:[0,1,0] op_sel_hi:[1,1,1]
    v_pk_fma_f32 v[206:207], v[126:127], v[240:241], v[206:207] op_sel:[0,1,0] op_sel_hi:[1,1,1]
    v_exp_f32 v208, v192
    v_exp_f32 v209, v193
    v_exp_f32 v210, v194
    v_exp_f32 v211, v195
    v_exp_f32 v212, v196
    v_exp_f32 v213, v197
    v_exp_f32 v214, v198
    v_exp_f32 v215, v199
    v_exp_f32 v216, v200
    v_exp_f32 v217, v201
    v_exp_f32 v218, v202
    v_exp_f32 v219, v203
    v_exp_f32 v220, v204
    v_exp_f32 v221, v205
    v_exp_f32 v222, v206
    v_exp_f32 v223, v207
    v_pk_add_f32 v[208:209], v[208:209], 1.0 op_sel_hi:[1,0]
    v_pk_add_f32 v[210:211], v[210:211], 1.0 op_sel_hi:[1,0]
    v_pk_add_f32 v[212:213], v[212:213], 1.0 op_sel_hi:[1,0]
    v_pk_add_f32 v[214:215], v[214:215], 1.0 op_sel_hi:[1,0]
    v_pk_add_f32 v[216:217], v[216:217], 1.0 op_sel_hi:[1,0]
    v_pk_add_f32 v[218:219], v[218:219], 1.0 op_sel_hi:[1,0]
    v_pk_add_f32 v[220:221], v[220:221], 1.0 op_sel_hi:[1,0]
    v_pk_add_f32 v[222:223], v[222:223], 1.0 op_sel_hi:[1,0]
    v_pk_fma_f32 v[208:209], v[208:209], v[208:209], 1.0 op_sel_hi:[1,1,0]
    v_pk_fma_f32 v[210:211], v[210:211], v[210:211], 1.0 op_sel_hi:[1,1,0]
    v_pk_fma_f32 v[212:213], v[212:213], v[212:213], 1.0 op_sel_hi:[1,1,0]
    v_pk_fma_f32 v[214:215], v[214:215], v[214:215], 1.0 op_sel_hi:[1,1,0]
    v_pk_fma_f32 v[216:217], v[216:217], v[216:217], 1.0 op_sel_hi:[1,1,0]
    v_pk_fma_f32 v[218:219], v[218:219], v[218:219], 1.0 op_sel_hi:[1,1,0]
    v_pk_fma_f32 v[220:221], v[220:221], v[220:221], 1.0 op_sel_hi:[1,1,0]
    v_pk_fma_f32 v[222:223], v[222:223], v[222:223], 1.0 op_sel_hi:[1,1,0]
    v_rcp_f32 v208, v208
    v_rcp_f32 v209, v209
    v_rcp_f32 v210, v210
    v_rcp_f32 v211, v211
    v_rcp_f32 v212, v212
    v_rcp_f32 v213, v213
    v_rcp_f32 v214, v214
    v_rcp_f32 v215, v215
    v_rcp_f32 v216, v216
    v_rcp_f32 v217, v217
    v_rcp_f32 v218, v218
    v_rcp_f32 v219, v219
    v_rcp_f32 v220, v220
    v_rcp_f32 v221, v221
    v_rcp_f32 v222, v222
    v_rcp_f32 v223, v223
    v_pk_fma_f32 v[208:209], v[208:209], v[232:233], v[232:233] op_sel:[0,0,1] op_sel_hi:[1,0,1]
    v_pk_fma_f32 v[210:211], v[210:211], v[232:233], v[232:233] op_sel:[0,0,1] op_sel_hi:[1,0,1]
    v_pk_fma_f32 v[212:213], v[212:213], v[232:233], v[232:233] op_sel:[0,0,1] op_sel_hi:[1,0,1]
    v_pk_fma_f32 v[214:215], v[214:215], v[232:233], v[232:233] op_sel:[0,0,1] op_sel_hi:[1,0,1]
    v_pk_fma_f32 v[216:217], v[216:217], v[232:233], v[232:233] op_sel:[0,0,1] op_sel_hi:[1,0,1]
    v_pk_fma_f32 v[218:219], v[218:219], v[232:233], v[232:233] op_sel:[0,0,1] op_sel_hi:[1,0,1]
    v_pk_fma_f32 v[220:221], v[220:221], v[232:233], v[232:233] op_sel:[0,0,1] op_sel_hi:[1,0,1]
    v_pk_fma_f32 v[222:223], v[222:223], v[232:233], v[232:233] op_sel:[0,0,1] op_sel_hi:[1,0,1]
    v_pk_mul_f32 v[208:209], v[208:209], v[192:193]
    v_pk_mul_f32 v[210:211], v[210:211], v[194:195]
    v_pk_mul_f32 v[212:213], v[212:213], v[196:197]
    v_pk_mul_f32 v[214:215], v[214:215], v[198:199]
    v_pk_mul_f32 v[216:217], v[216:217], v[200:201]
    v_pk_mul_f32 v[218:219], v[218:219], v[202:203]
    v_pk_mul_f32 v[220:221], v[220:221], v[204:205]
    v_pk_mul_f32 v[222:223], v[222:223], v[206:207]
    v_cvt_pk_bf16_f32 v112, v208, v209
    v_cvt_pk_bf16_f32 v113, v210, v211
    v_cvt_pk_bf16_f32 v114, v212, v213
    v_cvt_pk_bf16_f32 v115, v214, v215
    v_cvt_pk_bf16_f32 v116, v216, v217
    v_cvt_pk_bf16_f32 v117, v218, v219
    v_cvt_pk_bf16_f32 v118, v220, v221
    v_cvt_pk_bf16_f32 v119, v222, v223
    s_waitcnt lgkmcnt(0)
    s_xor_b64 s[44:45], s[44:45], s[42:43]
    s_xor_b64 s[46:47], s[46:47], s[42:43]
    s_or_b64 s[44:45], s[44:45], s[46:47]
    s_cbranch_scc1 L_chkm_21
L_chkd_20:
    s_add_u32 s70, s16, 0
    buffer_load_dwordx4 v[80:83], v248, s[52:55], s70 offen offset:0 sc1
    buffer_load_dwordx4 v[84:87], v248, s[52:55], s70 offen offset:1024 sc1
    v_xor_b32 v244, 0, v15
    v_add_u32 v252, 81920, v244
    v_xor_b32 v245, 32, v15
    v_add_u32 v253, 81920, v245
    v_xor_b32_e64 v246, 64, v15
    v_add_u32 v254, 81920, v246
    v_xor_b32 v247, 96, v15
    v_add_u32 v255, 81920, v247
    ds_read_b64_tr_b16 v[128:129], v252 offset:32768
    ds_read_b64_tr_b16 v[130:131], v252 offset:34816
    ds_read_b64_tr_b16 v[132:133], v252 offset:36864
    ds_read_b64_tr_b16 v[134:135], v252 offset:38912
    ds_read_b64_tr_b16 v[136:137], v253 offset:32768
    ds_read_b64_tr_b16 v[138:139], v253 offset:34816
    ds_read_b64_tr_b16 v[140:141], v253 offset:36864
    ds_read_b64_tr_b16 v[142:143], v253 offset:38912
    ds_read_b64_tr_b16 v[144:145], v254 offset:32768
    ds_read_b64_tr_b16 v[146:147], v254 offset:34816
    ds_read_b64_tr_b16 v[148:149], v254 offset:36864
    ds_read_b64_tr_b16 v[150:151], v254 offset:38912
    ds_read_b64_tr_b16 v[152:153], v255 offset:32768
    ds_read_b64_tr_b16 v[154:155], v255 offset:34816
    ds_read_b64_tr_b16 v[156:157], v255 offset:36864
    ds_read_b64_tr_b16 v[158:159], v255 offset:38912
    ds_read_b64_tr_b16 v[160:161], v244 offset:0
    ds_read_b64_tr_b16 v[162:163], v244 offset:2048
    ds_read_b64_tr_b16 v[164:165], v244 offset:4096
    ds_read_b64_tr_b16 v[166:167], v244 offset:6144
    ds_read_b64_tr_b16 v[168:169], v245 offset:0
    ds_read_b64_tr_b16 v[170:171], v245 offset:2048
    ds_read_b64_tr_b16 v[172:173], v245 offset:4096
    ds_read_b64_tr_b16 v[174:175], v245 offset:6144
    ds_read_b64_tr_b16 v[176:177], v246 offset:0
    ds_read_b64_tr_b16 v[178:179], v246 offset:2048
    ds_read_b64_tr_b16 v[180:181], v246 offset:4096
    ds_read_b64_tr_b16 v[182:183], v246 offset:6144
    ds_read_b64_tr_b16 v[184:185], v247 offset:0
    ds_read_b64_tr_b16 v[186:187], v247 offset:2048
    ds_read_b64_tr_b16 v[188:189], v247 offset:4096
    ds_read_b64_tr_b16 v[190:191], v247 offset:6144
    ds_read_b64_tr_b16 v[192:193], v252 offset:0
    ds_read_b64_tr_b16 v[194:195], v252 offset:2048
    ds_read_b64_tr_b16 v[196:197], v252 offset:4096
    ds_read_b64_tr_b16 v[198:199], v252 offset:6144
    ds_read_b64_tr_b16 v[200:201], v253 offset:0
    ds_read_b64_tr_b16 v[202:203], v253 offset:2048
    ds_read_b64_tr_b16 v[204:205], v253 offset:4096
    ds_read_b64_tr_b16 v[206:207], v253 offset:6144
    ds_read_b64_tr_b16 v[208:209], v254 offset:0
    ds_read_b64_tr_b16 v[210:211], v254 offset:2048
    ds_read_b64_tr_b16 v[212:213], v254 offset:4096
    ds_read_b64_tr_b16 v[214:215], v254 offset:6144
    ds_read_b64_tr_b16 v[216:217], v255 offset:0
    ds_read_b64_tr_b16 v[218:219], v255 offset:2048
    ds_read_b64_tr_b16 v[220:221], v255 offset:4096
    ds_read_b64_tr_b16 v[222:223], v255 offset:6144
    v_mov_b32 v2, -1
    ds_write_b32 v229, v2 offset:64
    s_waitcnt vmcnt(2) lgkmcnt(0)
    s_atomic_swap s68, s[66:67], 4096
    s_load_dwordx4 s[60:63], s[40:41], 1024 glc
    buffer_load_dwordx4 v[88:91], v249, s[52:55], s70 offen offset:0 sc1
    buffer_load_dwordx4 v[92:95], v249, s[52:55], s70 offen offset:1024 sc1
    buffer_load_dwordx4 v[96:99], v250, s[52:55], s70 offen offset:0 sc1
    buffer_load_dwordx4 v[100:103], v250, s[52:55], s70 offen offset:1024 sc1
    buffer_store_dwordx4 v[112:115], v225, s[52:55], s78 offen sc1
    buffer_store_dwordx4 v[116:119], v226, s[52:55], s78 offen sc1
    s_branch L_p2
L_compute_A:
    s_lshl_b32 s70, s5, 2
    s_add_u32 s70, s70, s3
    s_nop 0
    s_mul_i32 s25, s70, 18432
    s_add_u32 s25, s25, 327680
    s_mul_i32 s26, s4, 1152
    s_add_u32 s26, s26, s25
    s_and_b32 s72, s68, 1
    s_and_b32 s70, s4, 8
    s_mul_i32 s70, s70, 1152
    s_add_u32 s32, s25, s70
    s_sub_u32 s33, s25, s70
    s_lshr_b64 s[70:71], s[68:69], 0
    s_and_b32 s28, s70, 0xffe
    s_or_b32 s28, s28, s72
    s_lshr_b64 s[70:71], s[68:69], 12
    s_and_b32 s29, s70, 0xffe
    s_or_b32 s29, s29, s72
    s_lshr_b64 s[70:71], s[68:69], 24
    s_and_b32 s30, s70, 0xffe
    s_or_b32 s30, s30, s72
    s_lshr_b64 s[70:71], s[68:69], 36
    s_and_b32 s31, s70, 0xffe
    s_or_b32 s31, s31, s72
    s_lshl_b32 s72, s5, 1
    s_add_u32 s72, s72, s12
    s_lshl_b32 s72, s72, 10
    s_add_u32 s72, s72, 2154496
    v_lshl_add_u32 v6, v227, 4, s74
    v_xor_b32 v7, 128, v6
    v_xor_b32_e64 v14, 64, v224
    v_mov_b32 v230, 0x35c1a2a0
    v_mov_b32 v231, 0x3f317218
    v_mov_b32 v252, 0x3f803f80
    v_mov_b32 v253, 0x3f803f80
    v_mov_b32 v254, 0x3f803f80
    v_mov_b32 v255, 0x3f803f80
    s_waitcnt vmcnt(0)
    v_lshlrev_b32 v9, 4, v227
    v_lshl_add_u32 v8, v228, 6, v9
    v_cmp_gt_u32 vcc, 2, v228
    v_mov_b32 v10, 0x7ff00000
    v_mul_u32_u24 v11, 1152, v228
    v_add_u32 v11, v11, v9
    v_cndmask_b32 v8, v10, v8, vcc
    v_mov_b32 v10, 0xfff
    v_xor_b32 v9, 4, v229
    s_add_u32 s76, s76, s72
    s_add_u32 s77, s77, s72
    s_waitcnt lgkmcnt(0)
    s_barrier
    ds_read_b64_tr_b16 v[160:161], v216 offset:0
    ds_read_b64_tr_b16 v[162:163], v216 offset:512
    ds_read_b64_tr_b16 v[164:165], v218 offset:0
    ds_read_b64_tr_b16 v[166:167], v218 offset:512
    ds_read_b64_tr_b16 v[168:169], v216 offset:8192
    ds_read_b128 v[128:131], v212 offset:0
    ds_read_b128 v[132:135], v214 offset:0
    ds_read_b64_tr_b16 v[170:171], v216 offset:8704
    ds_read_b128 v[136:139], v212 offset:2048
    ds_read_b128 v[140:143], v214 offset:2048
    ds_read_b64_tr_b16 v[172:173], v218 offset:8192
    ds_read_b128 v[144:147], v213 offset:0
    ds_read_b128 v[148:151], v215 offset:0
    ds_read_b64_tr_b16 v[174:175], v218 offset:8704
    ds_read_b128 v[152:155], v213 offset:2048
    ds_read_b128 v[156:159], v215 offset:2048
    s_waitcnt lgkmcnt(12)
    v_mfma_f32_16x16x32_bf16 v[192:195], v[208:211], v[160:163], 0
    ds_read_b64_tr_b16 v[176:177], v216 offset:16384
    v_mfma_f32_16x16x32_bf16 v[192:195], v[208:211], v[164:167], v[192:195]
    ds_read_b64_tr_b16 v[178:179], v216 offset:16896
    s_waitcnt lgkmcnt(11)
    v_mfma_f32_16x16x32_bf16 v[16:19], v[160:163], v[128:131], 0
    ds_read_b64_tr_b16 v[180:181], v218 offset:16384
    v_mfma_f32_16x16x32_bf16 v[16:19], v[164:167], v[132:135], v[16:19]
    ds_read_b64_tr_b16 v[182:183], v218 offset:16896
    s_waitcnt lgkmcnt(10)
    v_mfma_f32_16x16x32_bf16 v[24:27], v[160:163], v[136:139], 0
    s_add_u32 s15, s15, 1
    v_mfma_f32_16x16x32_bf16 v[24:27], v[164:167], v[140:143], v[24:27]
    s_cmp_eq_u32 s15, 3
    s_waitcnt lgkmcnt(7)
    v_mfma_f32_16x16x32_bf16 v[32:35], v[160:163], v[144:147], 0
    s_cselect_b32 s13, s22, 45056
    v_mfma_f32_16x16x32_bf16 v[32:35], v[164:167], v[148:151], v[32:35]
    s_cselect_b32 s15, 0, s15
    s_waitcnt lgkmcnt(4)
    v_mfma_f32_16x16x32_bf16 v[40:43], v[160:163], v[152:155], 0
    v_mfma_f32_16x16x32_bf16 v[40:43], v[164:167], v[156:159], v[40:43]
    s_waitcnt lgkmcnt(6)
    v_mfma_f32_16x16x32_bf16 v[196:199], v[208:211], v[168:171], 0
    ds_write_b32 v224, v192 offset:0
    v_mfma_f32_16x16x32_bf16 v[196:199], v[208:211], v[172:175], v[196:199]
    ds_read_b64_tr_b16 v[160:161], v217 offset:0
    v_mfma_f32_16x16x32_bf16 v[48:51], v[128:131], v[168:171], 0
    ds_read_b64_tr_b16 v[162:163], v217 offset:512
    v_mfma_f32_16x16x32_bf16 v[48:51], v[132:135], v[172:175], v[48:51]
    ds_read_b64_tr_b16 v[164:165], v219 offset:0
    v_mfma_f32_16x16x32_bf16 v[56:59], v[136:139], v[168:171], 0
    ds_read_b64_tr_b16 v[166:167], v219 offset:512
    v_mfma_f32_16x16x32_bf16 v[56:59], v[140:143], v[172:175], v[56:59]
    v_add_u32 v216, s13, v216
    v_mfma_f32_16x16x32_bf16 v[64:67], v[144:147], v[168:171], 0
    v_add_u32 v218, s13, v218
    v_mfma_f32_16x16x32_bf16 v[64:67], v[148:151], v[172:175], v[64:67]
    v_add_u32 v212, s13, v212
    v_mfma_f32_16x16x32_bf16 v[72:75], v[152:155], v[168:171], 0
    v_add_u32 v213, s13, v213
    v_mfma_f32_16x16x32_bf16 v[72:75], v[156:159], v[172:175], v[72:75]
    s_waitcnt lgkmcnt(5)
    v_mfma_f32_16x16x32_bf16 v[200:203], v[208:211], v[176:179], 0
    ds_write_b32 v224, v196 offset:128
    v_mfma_f32_16x16x32_bf16 v[200:203], v[208:211], v[180:183], v[200:203]
    ds_read_b64_tr_b16 v[168:169], v217 offset:8192
    v_mfma_f32_16x16x32_bf16 v[80:83], v[128:131], v[176:179], 0
    ds_read_b64_tr_b16 v[170:171], v217 offset:8704
    v_mfma_f32_16x16x32_bf16 v[80:83], v[132:135], v[180:183], v[80:83]
    ds_read_b64_tr_b16 v[172:173], v219 offset:8192
    v_mfma_f32_16x16x32_bf16 v[88:91], v[136:139], v[176:179], 0
    ds_read_b64_tr_b16 v[174:175], v219 offset:8704
    v_mfma_f32_16x16x32_bf16 v[88:91], v[140:143], v[180:183], v[88:91]
    v_add_u32 v214, s13, v214
    v_mfma_f32_16x16x32_bf16 v[96:99], v[144:147], v[176:179], 0
    v_add_u32 v215, s13, v215
    v_mfma_f32_16x16x32_bf16 v[96:99], v[148:151], v[180:183], v[96:99]
    v_mfma_f32_16x16x32_bf16 v[104:107], v[152:155], v[176:179], 0
    v_mfma_f32_16x16x32_bf16 v[104:107], v[156:159], v[180:183], v[104:107]
    s_waitcnt lgkmcnt(5)
    v_mfma_f32_16x16x32_bf16 v[20:23], v[160:163], v[128:131], 0
    ds_write_b32 v224, v200 offset:256
    v_mfma_f32_16x16x32_bf16 v[20:23], v[164:167], v[132:135], v[20:23]
    ds_read_b64_tr_b16 v[176:177], v217 offset:16384
    v_mfma_f32_16x16x32_bf16 v[28:31], v[160:163], v[136:139], 0
    ds_read_b64_tr_b16 v[178:179], v217 offset:16896
    v_mfma_f32_16x16x32_bf16 v[28:31], v[164:167], v[140:143], v[28:31]
    ds_read_b64_tr_b16 v[180:181], v219 offset:16384
    v_mfma_f32_16x16x32_bf16 v[36:39], v[160:163], v[144:147], 0
    ds_read_b64_tr_b16 v[182:183], v219 offset:16896
    v_mfma_f32_16x16x32_bf16 v[36:39], v[164:167], v[148:151], v[36:39]
    v_mfma_f32_16x16x32_bf16 v[44:47], v[160:163], v[152:155], 0
    v_mfma_f32_16x16x32_bf16 v[44:47], v[164:167], v[156:159], v[44:47]
    s_waitcnt lgkmcnt(5)
    v_mfma_f32_16x16x32_bf16 v[52:55], v[128:131], v[168:171], v[52:55]
    v_mfma_f32_16x16x32_bf16 v[52:55], v[132:135], v[172:175], v[52:55]
L_kloop_22:
    s_waitcnt lgkmcnt(0)
    s_barrier
    v_mfma_f32_16x16x32_bf16 v[60:63], v[136:139], v[168:171], v[60:63]
    ds_read_b64_tr_b16 v[160:161], v216 offset:0
    v_mfma_f32_16x16x32_bf16 v[60:63], v[140:143], v[172:175], v[60:63]
    ds_read_b64_tr_b16 v[162:163], v216 offset:512
    v_mfma_f32_16x16x32_bf16 v[68:71], v[144:147], v[168:171], v[68:71]
    ds_read_b64_tr_b16 v[164:165], v218 offset:0
    v_mfma_f32_16x16x32_bf16 v[68:71], v[148:151], v[172:175], v[68:71]
    ds_read_b64_tr_b16 v[166:167], v218 offset:512
    v_mfma_f32_16x16x32_bf16 v[76:79], v[152:155], v[168:171], v[76:79]
    v_add_u32 v217, s13, v217
    v_mfma_f32_16x16x32_bf16 v[76:79], v[156:159], v[172:175], v[76:79]
    v_add_u32 v219, s13, v219
    v_mfma_f32_16x16x32_bf16 v[84:87], v[128:131], v[176:179], v[84:87]
    ds_read_b64_tr_b16 v[168:169], v216 offset:8192
    v_mfma_f32_16x16x32_bf16 v[84:87], v[132:135], v[180:183], v[84:87]
    ds_read_b128 v[128:131], v212 offset:0
    ds_read_b128 v[132:135], v214 offset:0
    v_mfma_f32_16x16x32_bf16 v[92:95], v[136:139], v[176:179], v[92:95]
    ds_read_b64_tr_b16 v[170:171], v216 offset:8704
    v_mfma_f32_16x16x32_bf16 v[92:95], v[140:143], v[180:183], v[92:95]
    ds_read_b128 v[136:139], v212 offset:2048
    ds_read_b128 v[140:143], v214 offset:2048
    v_mfma_f32_16x16x32_bf16 v[100:103], v[144:147], v[176:179], v[100:103]
    ds_read_b64_tr_b16 v[172:173], v218 offset:8192
    v_mfma_f32_16x16x32_bf16 v[100:103], v[148:151], v[180:183], v[100:103]
    ds_read_b128 v[144:147], v213 offset:0
    ds_read_b128 v[148:151], v215 offset:0
    v_mfma_f32_16x16x32_bf16 v[108:111], v[152:155], v[176:179], v[108:111]
    ds_read_b64_tr_b16 v[174:175], v218 offset:8704
    v_mfma_f32_16x16x32_bf16 v[108:111], v[156:159], v[180:183], v[108:111]
    ds_read_b128 v[152:155], v213 offset:2048
    ds_read_b128 v[156:159], v215 offset:2048
    s_waitcnt lgkmcnt(12)
    s_waitcnt lgkmcnt(9)
    v_mfma_f32_16x16x32_bf16 v[16:19], v[160:163], v[128:131], v[16:19]
    ds_read_b64_tr_b16 v[176:177], v216 offset:16384
    v_mfma_f32_16x16x32_bf16 v[16:19], v[164:167], v[132:135], v[16:19]
    ds_read_b64_tr_b16 v[178:179], v216 offset:16896
    s_waitcnt lgkmcnt(8)
    v_mfma_f32_16x16x32_bf16 v[24:27], v[160:163], v[136:139], v[24:27]
    ds_read_b64_tr_b16 v[180:181], v218 offset:16384
    v_mfma_f32_16x16x32_bf16 v[24:27], v[164:167], v[140:143], v[24:27]
    ds_read_b64_tr_b16 v[182:183], v218 offset:16896
    s_waitcnt lgkmcnt(7)
    v_mfma_f32_16x16x32_bf16 v[32:35], v[160:163], v[144:147], v[32:35]
    s_add_u32 s15, s15, 1
    v_mfma_f32_16x16x32_bf16 v[32:35], v[164:167], v[148:151], v[32:35]
    s_cmp_eq_u32 s15, 3
    s_waitcnt lgkmcnt(4)
    v_mfma_f32_16x16x32_bf16 v[40:43], v[160:163], v[152:155], v[40:43]
    s_cselect_b32 s13, s22, 45056
    v_mfma_f32_16x16x32_bf16 v[40:43], v[164:167], v[156:159], v[40:43]
    s_cselect_b32 s15, 0, s15
    s_waitcnt lgkmcnt(6)
    v_mfma_f32_16x16x32_bf16 v[48:51], v[128:131], v[168:171], v[48:51]
    ds_read_b64_tr_b16 v[160:161], v217 offset:0
    v_mfma_f32_16x16x32_bf16 v[48:51], v[132:135], v[172:175], v[48:51]
    ds_read_b64_tr_b16 v[162:163], v217 offset:512
    v_mfma_f32_16x16x32_bf16 v[56:59], v[136:139], v[168:171], v[56:59]
    ds_read_b64_tr_b16 v[164:165], v219 offset:0
    v_mfma_f32_16x16x32_bf16 v[56:59], v[140:143], v[172:175], v[56:59]
    ds_read_b64_tr_b16 v[166:167], v219 offset:512
    v_mfma_f32_16x16x32_bf16 v[64:67], v[144:147], v[168:171], v[64:67]
    v_add_u32 v216, s13, v216
    v_mfma_f32_16x16x32_bf16 v[64:67], v[148:151], v[172:175], v[64:67]
    v_add_u32 v218, s13, v218
    v_mfma_f32_16x16x32_bf16 v[72:75], v[152:155], v[168:171], v[72:75]
    v_add_u32 v212, s13, v212
    v_mfma_f32_16x16x32_bf16 v[72:75], v[156:159], v[172:175], v[72:75]
    v_add_u32 v213, s13, v213
    s_waitcnt lgkmcnt(4)
    v_mfma_f32_16x16x32_bf16 v[80:83], v[128:131], v[176:179], v[80:83]
    ds_read_b64_tr_b16 v[168:169], v217 offset:8192
    v_mfma_f32_16x16x32_bf16 v[80:83], v[132:135], v[180:183], v[80:83]
    ds_read_b64_tr_b16 v[170:171], v217 offset:8704
    v_mfma_f32_16x16x32_bf16 v[88:91], v[136:139], v[176:179], v[88:91]
    ds_read_b64_tr_b16 v[172:173], v219 offset:8192
    v_mfma_f32_16x16x32_bf16 v[88:91], v[140:143], v[180:183], v[88:91]
    ds_read_b64_tr_b16 v[174:175], v219 offset:8704
    v_mfma_f32_16x16x32_bf16 v[96:99], v[144:147], v[176:179], v[96:99]
    v_add_u32 v214, s13, v214
    v_mfma_f32_16x16x32_bf16 v[96:99], v[148:151], v[180:183], v[96:99]
    v_add_u32 v215, s13, v215
    v_mfma_f32_16x16x32_bf16 v[104:107], v[152:155], v[176:179], v[104:107]
    s_add_u32 s14, s14, 1
    v_mfma_f32_16x16x32_bf16 v[104:107], v[156:159], v[180:183], v[104:107]
    s_cmp_lt_u32 s14, 7
    s_waitcnt lgkmcnt(4)
    v_mfma_f32_16x16x32_bf16 v[20:23], v[160:163], v[128:131], v[20:23]
    ds_read_b64_tr_b16 v[176:177], v217 offset:16384
    v_mfma_f32_16x16x32_bf16 v[20:23], v[164:167], v[132:135], v[20:23]
    ds_read_b64_tr_b16 v[178:179], v217 offset:16896
    v_mfma_f32_16x16x32_bf16 v[28:31], v[160:163], v[136:139], v[28:31]
    ds_read_b64_tr_b16 v[180:181], v219 offset:16384
    v_mfma_f32_16x16x32_bf16 v[28:31], v[164:167], v[140:143], v[28:31]
    ds_read_b64_tr_b16 v[182:183], v219 offset:16896
    v_mfma_f32_16x16x32_bf16 v[36:39], v[160:163], v[144:147], v[36:39]
    v_mfma_f32_16x16x32_bf16 v[36:39], v[164:167], v[148:151], v[36:39]
    v_mfma_f32_16x16x32_bf16 v[44:47], v[160:163], v[152:155], v[44:47]
    v_mfma_f32_16x16x32_bf16 v[44:47], v[164:167], v[156:159], v[44:47]
    s_waitcnt lgkmcnt(4)
    v_mfma_f32_16x16x32_bf16 v[52:55], v[128:131], v[168:171], v[52:55]
    v_mfma_f32_16x16x32_bf16 v[52:55], v[132:135], v[172:175], v[52:55]
    s_cbranch_scc1 L_kloop_22
    s_waitcnt lgkmcnt(0)
    s_barrier
    v_mfma_f32_16x16x32_bf16 v[60:63], v[136:139], v[168:171], v[60:63]
    ds_read_b32 v160, v224 offset:128
    v_mfma_f32_16x16x32_bf16 v[60:63], v[140:143], v[172:175], v[60:63]
    ds_read_b32 v161, v14 offset:128
    v_mfma_f32_16x16x32_bf16 v[68:71], v[144:147], v[168:171], v[68:71]
    ds_read_b32 v162, v224 offset:256
    v_mfma_f32_16x16x32_bf16 v[68:71], v[148:151], v[172:175], v[68:71]
    ds_read_b32 v163, v14 offset:256
    v_mfma_f32_16x16x32_bf16 v[76:79], v[152:155], v[168:171], v[76:79]
    v_mfma_f32_16x16x32_bf16 v[76:79], v[156:159], v[172:175], v[76:79]
    v_mfma_f32_16x16x32_bf16 v[84:87], v[128:131], v[176:179], v[84:87]
    v_mfma_f32_16x16x32_bf16 v[84:87], v[132:135], v[180:183], v[84:87]
    ds_read_b128 v[128:131], v6 offset:512
    ds_read_b128 v[132:135], v6 offset:576
    v_mfma_f32_16x16x32_bf16 v[92:95], v[136:139], v[176:179], v[92:95]
    v_mfma_f32_16x16x32_bf16 v[92:95], v[140:143], v[180:183], v[92:95]
    ds_read_b128 v[136:139], v7 offset:512
    ds_read_b128 v[140:143], v7 offset:576
    v_mfma_f32_16x16x32_bf16 v[100:103], v[144:147], v[176:179], v[100:103]
    v_mfma_f32_16x16x32_bf16 v[100:103], v[148:151], v[180:183], v[100:103]
    ds_read_b128 v[144:147], v6 offset:0
    ds_read_b128 v[148:151], v6 offset:64
    v_mfma_f32_16x16x32_bf16 v[108:111], v[152:155], v[176:179], v[108:111]
    v_mfma_f32_16x16x32_bf16 v[108:111], v[156:159], v[180:183], v[108:111]
    ds_read_b128 v[152:155], v7 offset:0
    ds_read_b128 v[156:159], v7 offset:64
    ds_read_b128 v[164:167], v4
    ds_read_b128 v[168:171], v5
    ds_read_b32 v172, v2 offset:0
    ds_read_b32 v173, v2 offset:64
    ds_read_b32 v174, v3 offset:0
    ds_read_b32 v175, v3 offset:64
    ds_read_b32 v176, v2 offset:512
    ds_read_b32 v177, v2 offset:576
    ds_read_b32 v178, v3 offset:512
    ds_read_b32 v179, v3 offset:576
    s_lshl_b32 s70, s3, 11
    s_add_u32 s70, s70, 151552
    v_add_u32 v6, s70, v225
    v_xor_b32 v7, 0x800, v6
    s_waitcnt lgkmcnt(14)
    v_pk_fma_f32 v[192:193], v[128:129], v[160:161], v[230:231] op_sel:[0,1,0] op_sel_hi:[1,1,0]
    v_pk_fma_f32 v[194:195], v[130:131], v[160:161], v[230:231] op_sel:[0,1,0] op_sel_hi:[1,1,0]
    v_pk_fma_f32 v[196:197], v[132:133], v[160:161], v[230:231] op_sel:[0,1,0] op_sel_hi:[1,1,0]
    v_pk_fma_f32 v[198:199], v[134:135], v[160:161], v[230:231] op_sel:[0,1,0] op_sel_hi:[1,1,0]
    v_pk_fma_f32 v[200:201], v[136:137], v[160:161], v[230:231] op_sel:[0,1,0] op_sel_hi:[1,1,0]
    v_pk_fma_f32 v[202:203], v[138:139], v[160:161], v[230:231] op_sel:[0,1,0] op_sel_hi:[1,1,0]
    v_pk_fma_f32 v[204:205], v[140:141], v[160:161], v[230:231] op_sel:[0,1,0] op_sel_hi:[1,1,0]
    v_pk_fma_f32 v[206:207], v[142:143], v[160:161], v[230:231] op_sel:[0,1,0] op_sel_hi:[1,1,0]
    s_waitcnt lgkmcnt(10)
    s_nop 0
    v_pk_fma_f32 v[192:193], v[52:53], v[144:145], v[192:193]
    v_pk_fma_f32 v[194:195], v[54:55], v[146:147], v[194:195]
    v_pk_fma_f32 v[196:197], v[60:61], v[148:149], v[196:197]
    v_pk_fma_f32 v[198:199], v[62:63], v[150:151], v[198:199]
    v_pk_fma_f32 v[200:201], v[68:69], v[152:153], v[200:201]
    v_pk_fma_f32 v[202:203], v[70:71], v[154:155], v[202:203]
    v_pk_fma_f32 v[204:205], v[76:77], v[156:157], v[204:205]
    v_pk_fma_f32 v[206:207], v[78:79], v[158:159], v[206:207]
    v_exp_f32_e64 v112, v192 clamp
    v_exp_f32_e64 v113, v193 clamp
    v_exp_f32_e64 v114, v194 clamp
    v_exp_f32_e64 v115, v195 clamp
    v_exp_f32_e64 v116, v196 clamp
    v_exp_f32_e64 v117, v197 clamp
    v_exp_f32_e64 v118, v198 clamp
    v_exp_f32_e64 v119, v199 clamp
    v_exp_f32_e64 v120, v200 clamp
    v_exp_f32_e64 v121, v201 clamp
    v_exp_f32_e64 v122, v202 clamp
    v_exp_f32_e64 v123, v203 clamp
    v_exp_f32_e64 v124, v204 clamp
    v_exp_f32_e64 v125, v205 clamp
    v_exp_f32_e64 v126, v206 clamp
    v_exp_f32_e64 v127, v207 clamp
    v_max_f32 v192, v230, v192
    v_max_f32 v193, v230, v193
    v_max_f32 v194, v230, v194
    v_max_f32 v195, v230, v195
    v_max_f32 v196, v230, v196
    v_max_f32 v197, v230, v197
    v_max_f32 v198, v230, v198
    v_max_f32 v199, v230, v199
    v_max_f32 v200, v230, v200
    v_max_f32 v201, v230, v201
    v_max_f32 v202, v230, v202
    v_max_f32 v203, v230, v203
    v_max_f32 v204, v230, v204
    v_max_f32 v205, v230, v205
    v_max_f32 v206, v230, v206
    v_max_f32 v207, v230, v207
    v_pk_fma_f32 v[192:193], v[192:193], v[230:231], v[112:113] op_sel:[0,1,0] op_sel_hi:[1,1,1]
    v_pk_fma_f32 v[194:195], v[194:195], v[230:231], v[114:115] op_sel:[0,1,0] op_sel_hi:[1,1,1]
    v_pk_fma_f32 v[196:197], v[196:197], v[230:231], v[116:117] op_sel:[0,1,0] op_sel_hi:[1,1,1]
    v_pk_fma_f32 v[198:199], v[198:199], v[230:231], v[118:119] op_sel:[0,1,0] op_sel_hi:[1,1,1]
    v_pk_fma_f32 v[200:201], v[200:201], v[230:231], v[120:121] op_sel:[0,1,0] op_sel_hi:[1,1,1]
    v_pk_fma_f32 v[202:203], v[202:203], v[230:231], v[122:123] op_sel:[0,1,0] op_sel_hi:[1,1,1]
    v_pk_fma_f32 v[204:205], v[204:205], v[230:231], v[124:125] op_sel:[0,1,0] op_sel_hi:[1,1,1]
    v_pk_fma_f32 v[206:207], v[206:207], v[230:231], v[126:127] op_sel:[0,1,0] op_sel_hi:[1,1,1]
    v_cvt_pk_bf16_f32 v232, v192, v193
    v_cvt_pk_bf16_f32 v233, v194, v195
    v_cvt_pk_bf16_f32 v234, v196, v197
    v_cvt_pk_bf16_f32 v235, v198, v199
    v_cvt_pk_bf16_f32 v236, v200, v201
    v_cvt_pk_bf16_f32 v237, v202, v203
    v_cvt_pk_bf16_f32 v238, v204, v205
    v_cvt_pk_bf16_f32 v239, v206, v207
    v_pk_mul_f32 v[192:193], v[128:129], v[162:163] op_sel:[0,1] op_sel_hi:[1,1]
    v_pk_mul_f32 v[194:195], v[130:131], v[162:163] op_sel:[0,1] op_sel_hi:[1,1]
    v_pk_mul_f32 v[196:197], v[132:133], v[162:163] op_sel:[0,1] op_sel_hi:[1,1]
    v_pk_mul_f32 v[198:199], v[134:135], v[162:163] op_sel:[0,1] op_sel_hi:[1,1]
    v_pk_mul_f32 v[200:201], v[136:137], v[162:163] op_sel:[0,1] op_sel_hi:[1,1]
    v_pk_mul_f32 v[202:203], v[138:139], v[162:163] op_sel:[0,1] op_sel_hi:[1,1]
    v_pk_mul_f32 v[204:205], v[140:141], v[162:163] op_sel:[0,1] op_sel_hi:[1,1]
    v_pk_mul_f32 v[206:207], v[142:143], v[162:163] op_sel:[0,1] op_sel_hi:[1,1]
    v_pk_fma_f32 v[192:193], v[84:85], v[144:145], v[192:193]
    v_pk_fma_f32 v[194:195], v[86:87], v[146:147], v[194:195]
    v_pk_fma_f32 v[196:197], v[92:93], v[148:149], v[196:197]
    v_pk_fma_f32 v[198:199], v[94:95], v[150:151], v[198:199]
    v_pk_fma_f32 v[200:201], v[100:101], v[152:153], v[200:201]
    v_pk_fma_f32 v[202:203], v[102:103], v[154:155], v[202:203]
    v_pk_fma_f32 v[204:205], v[108:109], v[156:157], v[204:205]
    v_pk_fma_f32 v[206:207], v[110:111], v[158:159], v[206:207]
    v_cvt_pk_bf16_f32 v208, v192, v193
    v_cvt_pk_bf16_f32 v209, v194, v195
    v_cvt_pk_bf16_f32 v210, v196, v197
    v_cvt_pk_bf16_f32 v211, v198, v199
    v_cvt_pk_bf16_f32 v212, v200, v201
    v_cvt_pk_bf16_f32 v213, v202, v203
    v_cvt_pk_bf16_f32 v214, v204, v205
    v_cvt_pk_bf16_f32 v215, v206, v207
    v_mfma_f32_16x16x32_bf16 v[244:247], v[232:235], v[252:255], 0
    v_mfma_f32_16x16x32_bf16 v[244:247], v[236:239], v[252:255], v[244:247]
    v_mfma_f32_16x16x32_bf16 v[240:243], v[232:235], v[208:211], 0
    v_mfma_f32_16x16x32_bf16 v[240:243], v[236:239], v[212:215], v[240:243]
    v_pk_fma_f32 v[192:193], v[128:129], v[160:161], v[230:231] op_sel:[0,0,0] op_sel_hi:[1,0,0]
    v_pk_fma_f32 v[194:195], v[130:131], v[160:161], v[230:231] op_sel:[0,0,0] op_sel_hi:[1,0,0]
    v_pk_fma_f32 v[196:197], v[132:133], v[160:161], v[230:231] op_sel:[0,0,0] op_sel_hi:[1,0,0]
    v_pk_fma_f32 v[198:199], v[134:135], v[160:161], v[230:231] op_sel:[0,0,0] op_sel_hi:[1,0,0]
    v_pk_fma_f32 v[200:201], v[136:137], v[160:161], v[230:231] op_sel:[0,0,0] op_sel_hi:[1,0,0]
    v_pk_fma_f32 v[202:203], v[138:139], v[160:161], v[230:231] op_sel:[0,0,0] op_sel_hi:[1,0,0]
    v_pk_fma_f32 v[204:205], v[140:141], v[160:161], v[230:231] op_sel:[0,0,0] op_sel_hi:[1,0,0]
    v_pk_fma_f32 v[206:207], v[142:143], v[160:161], v[230:231] op_sel:[0,0,0] op_sel_hi:[1,0,0]
    v_pk_fma_f32 v[192:193], v[48:49], v[144:145], v[192:193]
    v_pk_fma_f32 v[194:195], v[50:51], v[146:147], v[194:195]
    v_pk_fma_f32 v[196:197], v[56:57], v[148:149], v[196:197]
    v_pk_fma_f32 v[198:199], v[58:59], v[150:151], v[198:199]
    v_pk_fma_f32 v[200:201], v[64:65], v[152:153], v[200:201]
    v_pk_fma_f32 v[202:203], v[66:67], v[154:155], v[202:203]
    v_pk_fma_f32 v[204:205], v[72:73], v[156:157], v[204:205]
    v_pk_fma_f32 v[206:207], v[74:75], v[158:159], v[206:207]
    ds_write_b128 v6, v[240:243]
    ds_write_b128 v6, v[244:247] offset:1024
    ds_write_b32 v229, v252 offset:32
    v_exp_f32_e64 v112, v192 clamp
    v_exp_f32_e64 v113, v193 clamp
    v_exp_f32_e64 v114, v194 clamp
    v_exp_f32_e64 v115, v195 clamp
    v_exp_f32_e64 v116, v196 clamp
    v_exp_f32_e64 v117, v197 clamp
    v_exp_f32_e64 v118, v198 clamp
    v_exp_f32_e64 v119, v199 clamp
    v_exp_f32_e64 v120, v200 clamp
    v_exp_f32_e64 v121, v201 clamp
    v_exp_f32_e64 v122, v202 clamp
    v_exp_f32_e64 v123, v203 clamp
    v_exp_f32_e64 v124, v204 clamp
    v_exp_f32_e64 v125, v205 clamp
    v_exp_f32_e64 v126, v206 clamp
    v_exp_f32_e64 v127, v207 clamp
    v_max_f32 v192, v230, v192
    v_max_f32 v193, v230, v193
    v_max_f32 v194, v230, v194
    v_max_f32 v195, v230, v195
    v_max_f32 v196, v230, v196
    v_max_f32 v197, v230, v197
    v_max_f32 v198, v230, v198
    v_max_f32 v199, v230, v199
    v_max_f32 v200, v230, v200
    v_max_f32 v201, v230, v201
    v_max_f32 v202, v230, v202
    v_max_f32 v203, v230, v203
    v_max_f32 v204, v230, v204
    v_max_f32 v205, v230, v205
    v_max_f32 v206, v230, v206
    v_max_f32 v207, v230, v207
    v_pk_fma_f32 v[192:193], v[192:193], v[230:231], v[112:113] op_sel:[0,1,0] op_sel_hi:[1,1,1]
    v_pk_fma_f32 v[194:195], v[194:195], v[230:231], v[114:115] op_sel:[0,1,0] op_sel_hi:[1,1,1]
    v_pk_fma_f32 v[196:197], v[196:197], v[230:231], v[116:117] op_sel:[0,1,0] op_sel_hi:[1,1,1]
    v_pk_fma_f32 v[198:199], v[198:199], v[230:231], v[118:119] op_sel:[0,1,0] op_sel_hi:[1,1,1]
    v_pk_fma_f32 v[200:201], v[200:201], v[230:231], v[120:121] op_sel:[0,1,0] op_sel_hi:[1,1,1]
    v_pk_fma_f32 v[202:203], v[202:203], v[230:231], v[122:123] op_sel:[0,1,0] op_sel_hi:[1,1,1]
    v_pk_fma_f32 v[204:205], v[204:205], v[230:231], v[124:125] op_sel:[0,1,0] op_sel_hi:[1,1,1]
    v_pk_fma_f32 v[206:207], v[206:207], v[230:231], v[126:127] op_sel:[0,1,0] op_sel_hi:[1,1,1]
    v_cvt_pk_bf16_f32 v232, v192, v193
    v_cvt_pk_bf16_f32 v233, v194, v195
    v_cvt_pk_bf16_f32 v234, v196, v197
    v_cvt_pk_bf16_f32 v235, v198, v199
    v_cvt_pk_bf16_f32 v236, v200, v201
    v_cvt_pk_bf16_f32 v237, v202, v203
    v_cvt_pk_bf16_f32 v238, v204, v205
    v_cvt_pk_bf16_f32 v239, v206, v207
    v_pk_mul_f32 v[192:193], v[128:129], v[162:163] op_sel:[0,0] op_sel_hi:[1,0]
    v_pk_mul_f32 v[194:195], v[130:131], v[162:163] op_sel:[0,0] op_sel_hi:[1,0]
    v_pk_mul_f32 v[196:197], v[132:133], v[162:163] op_sel:[0,0] op_sel_hi:[1,0]
    v_pk_mul_f32 v[198:199], v[134:135], v[162:163] op_sel:[0,0] op_sel_hi:[1,0]
    v_pk_mul_f32 v[200:201], v[136:137], v[162:163] op_sel:[0,0] op_sel_hi:[1,0]
    v_pk_mul_f32 v[202:203], v[138:139], v[162:163] op_sel:[0,0] op_sel_hi:[1,0]
    v_pk_mul_f32 v[204:205], v[140:141], v[162:163] op_sel:[0,0] op_sel_hi:[1,0]
    v_pk_mul_f32 v[206:207], v[142:143], v[162:163] op_sel:[0,0] op_sel_hi:[1,0]
    v_pk_fma_f32 v[192:193], v[80:81], v[144:145], v[192:193]
    v_pk_fma_f32 v[194:195], v[82:83], v[146:147], v[194:195]
    v_pk_fma_f32 v[196:197], v[88:89], v[148:149], v[196:197]
    v_pk_fma_f32 v[198:199], v[90:91], v[150:151], v[198:199]
    v_pk_fma_f32 v[200:201], v[96:97], v[152:153], v[200:201]
    v_pk_fma_f32 v[202:203], v[98:99], v[154:155], v[202:203]
    v_pk_fma_f32 v[204:205], v[104:105], v[156:157], v[204:205]
    v_pk_fma_f32 v[206:207], v[106:107], v[158:159], v[206:207]
    v_cvt_pk_bf16_f32 v208, v192, v193
    v_cvt_pk_bf16_f32 v209, v194, v195
    v_cvt_pk_bf16_f32 v210, v196, v197
    v_cvt_pk_bf16_f32 v211, v198, v199
    v_cvt_pk_bf16_f32 v212, v200, v201
    v_cvt_pk_bf16_f32 v213, v202, v203
    v_cvt_pk_bf16_f32 v214, v204, v205
    v_cvt_pk_bf16_f32 v215, v206, v207
    v_mfma_f32_16x16x32_bf16 v[188:191], v[232:235], v[252:255], 0
    v_mfma_f32_16x16x32_bf16 v[188:191], v[236:239], v[252:255], v[188:191]
    v_mfma_f32_16x16x32_bf16 v[184:187], v[232:235], v[208:211], 0
    v_mfma_f32_16x16x32_bf16 v[184:187], v[236:239], v[212:215], v[184:187]
    s_mov_b32 s79, 2000000
L_pair_23:
    ds_read_b32 v3, v9 offset:32
    ds_read_b128 v[112:115], v7
    ds_read_b128 v[116:119], v7 offset:1024
    s_waitcnt lgkmcnt(2)
    v_readfirstlane_b32 s75, v3
    s_nop 0
    s_cmp_eq_u32 s75, 0
    s_cbranch_scc1 L_pairm_24
L_paird_25:
    s_waitcnt lgkmcnt(1)
    v_add_f32 v184, v112, v184
    v_add_f32 v185, v113, v185
    v_add_f32 v186, v114, v186
    v_add_f32 v187, v115, v187
    v_add_u32 v184, 0x800, v184
    v_add_u32 v185, 0x800, v185
    v_add_u32 v186, 0x800, v186
    v_add_u32 v187, 0x800, v187
    v_bfi_b32 v184, v10, s28, v184
    v_bfi_b32 v185, v10, s29, v185
    v_bfi_b32 v186, v10, s30, v186
    v_bfi_b32 v187, v10, s31, v187
    buffer_store_dwordx4 v[184:187], v225, s[52:55], s26 offen sc1
    s_waitcnt lgkmcnt(0)
    v_add_f32_e64 v188, v116, v188
    v_add_f32 v189, v117, v189
    v_add_f32 v190, v118, v190
    v_add_f32 v191, v119, v191
    v_add_u32 v188, 0x800, v188
    v_add_u32 v189, 0x800, v189
    v_add_u32 v190, 0x800, v190
    v_add_u32 v191, 0x800, v191
    v_bfi_b32 v188, v10, s28, v188
    v_bfi_b32 v189, v10, s29, v189
    v_bfi_b32 v190, v10, s30, v190
    v_bfi_b32 v191, v10, s31, v191
    buffer_store_dwordx4 v[188:191], v8, s[52:55], s26 offen offset:1024 sc1
    v_pk_fma_f32 v[192:193], v[164:165], v[176:177], v[230:231] op_sel:[0,0,0] op_sel_hi:[1,0,0]
    v_pk_fma_f32 v[194:195], v[166:167], v[176:177], v[230:231] op_sel:[0,0,0] op_sel_hi:[1,0,0]
    v_pk_fma_f32 v[196:197], v[168:169], v[176:177], v[230:231] op_sel:[0,0,0] op_sel_hi:[1,0,0]
    v_pk_fma_f32 v[198:199], v[170:171], v[176:177], v[230:231] op_sel:[0,0,0] op_sel_hi:[1,0,0]
    v_pk_fma_f32 v[200:201], v[164:165], v[176:177], v[230:231] op_sel:[0,1,0] op_sel_hi:[1,1,0]
    v_pk_fma_f32 v[202:203], v[166:167], v[176:177], v[230:231] op_sel:[0,1,0] op_sel_hi:[1,1,0]
    v_pk_fma_f32 v[204:205], v[168:169], v[176:177], v[230:231] op_sel:[0,1,0] op_sel_hi:[1,1,0]
    v_pk_fma_f32 v[206:207], v[170:171], v[176:177], v[230:231] op_sel:[0,1,0] op_sel_hi:[1,1,0]
    v_pk_fma_f32 v[192:193], v[16:17], v[172:173], v[192:193] op_sel:[0,0,0] op_sel_hi:[1,0,1]
    v_pk_fma_f32 v[194:195], v[18:19], v[172:173], v[194:195] op_sel:[0,0,0] op_sel_hi:[1,0,1]
    v_pk_fma_f32 v[196:197], v[20:21], v[172:173], v[196:197] op_sel:[0,0,0] op_sel_hi:[1,0,1]
    v_pk_fma_f32 v[198:199], v[22:23], v[172:173], v[198:199] op_sel:[0,0,0] op_sel_hi:[1,0,1]
    v_pk_fma_f32 v[200:201], v[24:25], v[172:173], v[200:201] op_sel:[0,1,0] op_sel_hi:[1,1,1]
    v_pk_fma_f32 v[202:203], v[26:27], v[172:173], v[202:203] op_sel:[0,1,0] op_sel_hi:[1,1,1]
    v_pk_fma_f32 v[204:205], v[28:29], v[172:173], v[204:205] op_sel:[0,1,0] op_sel_hi:[1,1,1]
    v_pk_fma_f32 v[206:207], v[30:31], v[172:173], v[206:207] op_sel:[0,1,0] op_sel_hi:[1,1,1]
    v_exp_f32_e64 v112, v192 clamp
    v_exp_f32_e64 v113, v193 clamp
    v_exp_f32_e64 v114, v194 clamp
    v_exp_f32_e64 v115, v195 clamp
    v_exp_f32_e64 v116, v196 clamp
    v_exp_f32_e64 v117, v197 clamp
    v_exp_f32_e64 v118, v198 clamp
    v_exp_f32_e64 v119, v199 clamp
    v_exp_f32_e64 v120, v200 clamp
    v_exp_f32_e64 v121, v201 clamp
    v_exp_f32_e64 v122, v202 clamp
    v_exp_f32_e64 v123, v203 clamp
    v_exp_f32_e64 v124, v204 clamp
    v_exp_f32_e64 v125, v205 clamp
    v_exp_f32_e64 v126, v206 clamp
    v_exp_f32_e64 v127, v207 clamp
    v_max_f32 v192, v230, v192
    v_max_f32 v193, v230, v193
    v_max_f32 v194, v230, v194
    v_max_f32 v195, v230, v195
    v_max_f32 v196, v230, v196
    v_max_f32 v197, v230, v197
    v_max_f32 v198, v230, v198
    v_max_f32 v199, v230, v199
    v_max_f32 v200, v230, v200
    v_max_f32 v201, v230, v201
    v_max_f32 v202, v230, v202
    v_max_f32 v203, v230, v203
    v_max_f32 v204, v230, v204
    v_max_f32 v205, v230, v205
    v_max_f32 v206, v230, v206
    v_max_f32 v207, v230, v207
    v_pk_fma_f32 v[192:193], v[192:193], v[230:231], v[112:113] op_sel:[0,1,0] op_sel_hi:[1,1,1]
    v_pk_fma_f32 v[194:195], v[194:195], v[230:231], v[114:115] op_sel:[0,1,0] op_sel_hi:[1,1,1]
    v_pk_fma_f32 v[196:197], v[196:197], v[230:231], v[116:117] op_sel:[0,1,0] op_sel_hi:[1,1,1]
    v_pk_fma_f32 v[198:199], v[198:199], v[230:231], v[118:119] op_sel:[0,1,0] op_sel_hi:[1,1,1]
    v_pk_fma_f32 v[200:201], v[200:201], v[230:231], v[120:121] op_sel:[0,1,0] op_sel_hi:[1,1,1]
    v_pk_fma_f32 v[202:203], v[202:203], v[230:231], v[122:123] op_sel:[0,1,0] op_sel_hi:[1,1,1]
    v_pk_fma_f32 v[204:205], v[204:205], v[230:231], v[124:125] op_sel:[0,1,0] op_sel_hi:[1,1,1]
    v_pk_fma_f32 v[206:207], v[206:207], v[230:231], v[126:127] op_sel:[0,1,0] op_sel_hi:[1,1,1]
    v_cvt_pk_bf16_f32 v48, v192, v193
    v_cvt_pk_bf16_f32 v49, v194, v195
    v_cvt_pk_bf16_f32 v50, v196, v197
    v_cvt_pk_bf16_f32 v51, v198, v199
    v_cvt_pk_bf16_f32 v52, v200, v201
    v_cvt_pk_bf16_f32 v53, v202, v203
    v_cvt_pk_bf16_f32 v54, v204, v205
    v_cvt_pk_bf16_f32 v55, v206, v207
    v_mov_b32_e64 v2, s64
    ds_read_b128 v[244:247], v2 offset:16
    v_pk_fma_f32 v[192:193], v[164:165], v[178:179], v[230:231] op_sel:[0,0,0] op_sel_hi:[1,0,0]
    v_pk_fma_f32 v[194:195], v[166:167], v[178:179], v[230:231] op_sel:[0,0,0] op_sel_hi:[1,0,0]
    v_pk_fma_f32 v[196:197], v[168:169], v[178:179], v[230:231] op_sel:[0,0,0] op_sel_hi:[1,0,0]
    v_pk_fma_f32 v[198:199], v[170:171], v[178:179], v[230:231] op_sel:[0,0,0] op_sel_hi:[1,0,0]
    v_pk_fma_f32 v[200:201], v[164:165], v[178:179], v[230:231] op_sel:[0,1,0] op_sel_hi:[1,1,0]
    v_pk_fma_f32 v[202:203], v[166:167], v[178:179], v[230:231] op_sel:[0,1,0] op_sel_hi:[1,1,0]
    v_pk_fma_f32 v[204:205], v[168:169], v[178:179], v[230:231] op_sel:[0,1,0] op_sel_hi:[1,1,0]
    v_pk_fma_f32 v[206:207], v[170:171], v[178:179], v[230:231] op_sel:[0,1,0] op_sel_hi:[1,1,0]
    v_pk_fma_f32 v[192:193], v[32:33], v[174:175], v[192:193] op_sel:[0,0,0] op_sel_hi:[1,0,1]
    v_pk_fma_f32 v[194:195], v[34:35], v[174:175], v[194:195] op_sel:[0,0,0] op_sel_hi:[1,0,1]
    v_pk_fma_f32 v[196:197], v[36:37], v[174:175], v[196:197] op_sel:[0,0,0] op_sel_hi:[1,0,1]
    v_pk_fma_f32 v[198:199], v[38:39], v[174:175], v[198:199] op_sel:[0,0,0] op_sel_hi:[1,0,1]
    v_pk_fma_f32 v[200:201], v[40:41], v[174:175], v[200:201] op_sel:[0,1,0] op_sel_hi:[1,1,1]
    v_pk_fma_f32 v[202:203], v[42:43], v[174:175], v[202:203] op_sel:[0,1,0] op_sel_hi:[1,1,1]
    v_pk_fma_f32 v[204:205], v[44:45], v[174:175], v[204:205] op_sel:[0,1,0] op_sel_hi:[1,1,1]
    v_pk_fma_f32 v[206:207], v[46:47], v[174:175], v[206:207] op_sel:[0,1,0] op_sel_hi:[1,1,1]
    v_exp_f32_e64 v112, v192 clamp
    v_exp_f32_e64 v113, v193 clamp
    v_exp_f32_e64 v114, v194 clamp
    v_exp_f32_e64 v115, v195 clamp
    v_exp_f32_e64 v116, v196 clamp
    v_exp_f32_e64 v117, v197 clamp
    v_exp_f32_e64 v118, v198 clamp
    v_exp_f32_e64 v119, v199 clamp
    v_exp_f32_e64 v120, v200 clamp
    v_exp_f32_e64 v121, v201 clamp
    v_exp_f32_e64 v122, v202 clamp
    v_exp_f32_e64 v123, v203 clamp
    v_exp_f32_e64 v124, v204 clamp
    v_exp_f32_e64 v125, v205 clamp
    v_exp_f32_e64 v126, v206 clamp
    v_exp_f32_e64 v127, v207 clamp
    v_max_f32 v192, v230, v192
    v_max_f32 v193, v230, v193
    v_max_f32 v194, v230, v194
    v_max_f32 v195, v230, v195
    v_max_f32 v196, v230, v196
    v_max_f32 v197, v230, v197
    v_max_f32 v198, v230, v198
    v_max_f32 v199, v230, v199
    v_max_f32 v200, v230, v200
    v_max_f32 v201, v230, v201
    v_max_f32 v202, v230, v202
    v_max_f32 v203, v230, v203
    v_max_f32 v204, v230, v204
    v_max_f32 v205, v230, v205
    v_max_f32 v206, v230, v206
    v_max_f32 v207, v230, v207
    v_pk_fma_f32 v[192:193], v[192:193], v[230:231], v[112:113] op_sel:[0,1,0] op_sel_hi:[1,1,1]
    v_pk_fma_f32 v[194:195], v[194:195], v[230:231], v[114:115] op_sel:[0,1,0] op_sel_hi:[1,1,1]
    v_pk_fma_f32 v[196:197], v[196:197], v[230:231], v[116:117] op_sel:[0,1,0] op_sel_hi:[1,1,1]
    v_pk_fma_f32 v[198:199], v[198:199], v[230:231], v[118:119] op_sel:[0,1,0] op_sel_hi:[1,1,1]
    v_pk_fma_f32 v[200:201], v[200:201], v[230:231], v[120:121] op_sel:[0,1,0] op_sel_hi:[1,1,1]
    v_pk_fma_f32 v[202:203], v[202:203], v[230:231], v[122:123] op_sel:[0,1,0] op_sel_hi:[1,1,1]
    v_pk_fma_f32 v[204:205], v[204:205], v[230:231], v[124:125] op_sel:[0,1,0] op_sel_hi:[1,1,1]
    v_pk_fma_f32 v[206:207], v[206:207], v[230:231], v[126:127] op_sel:[0,1,0] op_sel_hi:[1,1,1]
    v_cvt_pk_bf16_f32 v56, v192, v193
    v_cvt_pk_bf16_f32 v57, v194, v195
    v_cvt_pk_bf16_f32 v58, v196, v197
    v_cvt_pk_bf16_f32 v59, v198, v199
    v_cvt_pk_bf16_f32 v60, v200, v201
    v_cvt_pk_bf16_f32 v61, v202, v203
    v_cvt_pk_bf16_f32 v62, v204, v205
    v_cvt_pk_bf16_f32 v63, v206, v207
    buffer_load_dwordx4 v[40:43], v1, s[36:39], s18 offen offset:0
    buffer_load_dwordx4 v[44:47], v1, s[36:39], s18 offen offset:64
    s_waitcnt lgkmcnt(0)
    v_and_b32 v244, v244, v245
    v_and_b32 v246, v246, v247
    v_and_b32 v244, v244, v246
    s_nop 0
    v_readfirstlane_b32 s75, v244
    s_nop 0
    s_cmp_eq_u32 s75, 0
    s_cbranch_scc1 L_landm_28
L_landd_27:
    v_xor_b32 v244, 0, v15
    v_add_u32 v252, 81920, v244
    v_xor_b32 v245, 32, v15
    v_add_u32 v253, 81920, v245
    v_xor_b32 v246, 64, v15
    v_add_u32 v254, 81920, v246
    v_xor_b32 v247, 96, v15
    v_add_u32 v255, 81920, v247
    ds_read_b64_tr_b16 v[128:129], v252 offset:32768
    ds_read_b64_tr_b16 v[130:131], v252 offset:34816
    ds_read_b64_tr_b16 v[132:133], v252 offset:36864
    ds_read_b64_tr_b16 v[134:135], v252 offset:38912
    ds_read_b64_tr_b16 v[136:137], v253 offset:32768
    ds_read_b64_tr_b16 v[138:139], v253 offset:34816
    ds_read_b64_tr_b16 v[140:141], v253 offset:36864
    ds_read_b64_tr_b16 v[142:143], v253 offset:38912
    ds_read_b64_tr_b16 v[144:145], v254 offset:32768
    ds_read_b64_tr_b16 v[146:147], v254 offset:34816
    ds_read_b64_tr_b16 v[148:149], v254 offset:36864
    ds_read_b64_tr_b16 v[150:151], v254 offset:38912
    ds_read_b64_tr_b16 v[152:153], v255 offset:32768
    ds_read_b64_tr_b16 v[154:155], v255 offset:34816
    ds_read_b64_tr_b16 v[156:157], v255 offset:36864
    ds_read_b64_tr_b16 v[158:159], v255 offset:38912
    ds_read_b64_tr_b16 v[160:161], v244 offset:0
    ds_read_b64_tr_b16 v[162:163], v244 offset:2048
    ds_read_b64_tr_b16 v[164:165], v244 offset:4096
    ds_read_b64_tr_b16 v[166:167], v244 offset:6144
    ds_read_b64_tr_b16 v[168:169], v245 offset:0
    ds_read_b64_tr_b16 v[170:171], v245 offset:2048
    ds_read_b64_tr_b16 v[172:173], v245 offset:4096
    ds_read_b64_tr_b16 v[174:175], v245 offset:6144
    ds_read_b64_tr_b16 v[176:177], v246 offset:0
    ds_read_b64_tr_b16 v[178:179], v246 offset:2048
    ds_read_b64_tr_b16 v[180:181], v246 offset:4096
    ds_read_b64_tr_b16 v[182:183], v246 offset:6144
    ds_read_b64_tr_b16 v[184:185], v247 offset:0
    ds_read_b64_tr_b16 v[186:187], v247 offset:2048
    ds_read_b64_tr_b16 v[188:189], v247 offset:4096
    ds_read_b64_tr_b16 v[190:191], v247 offset:6144
    ds_read_b64_tr_b16 v[192:193], v252 offset:0
    ds_read_b64_tr_b16 v[194:195], v252 offset:2048
    ds_read_b64_tr_b16 v[196:197], v252 offset:4096
    ds_read_b64_tr_b16 v[198:199], v252 offset:6144
    ds_read_b64_tr_b16 v[200:201], v253 offset:0
    ds_read_b64_tr_b16 v[202:203], v253 offset:2048
    ds_read_b64_tr_b16 v[204:205], v253 offset:4096
    ds_read_b64_tr_b16 v[206:207], v253 offset:6144
    ds_read_b64_tr_b16 v[208:209], v254 offset:0
    ds_read_b64_tr_b16 v[210:211], v254 offset:2048
    ds_read_b64_tr_b16 v[212:213], v254 offset:4096
    ds_read_b64_tr_b16 v[214:215], v254 offset:6144
    ds_read_b64_tr_b16 v[216:217], v255 offset:0
    ds_read_b64_tr_b16 v[218:219], v255 offset:2048
    ds_read_b64_tr_b16 v[220:221], v255 offset:4096
    ds_read_b64_tr_b16 v[222:223], v255 offset:6144
    v_mov_b32 v2, -1
    ds_write_b32 v229, v2 offset:64
    s_lshl_b32 s70, s3, 10
    s_add_u32 s70, s70, 159744
    v_add_u32 v6, s70, v225
    v_xor_b32 v7, 0x400, v6
    s_mov_b32 s79, 200000
L_gather_29:
    s_add_u32 s71, s32, 0
    buffer_load_dwordx4 v[64:67], v225, s[52:55], s71 offen offset:0 sc1
    buffer_load_dwordx4 v[68:71], v225, s[52:55], s71 offen offset:1152 sc1
    buffer_load_dwordx4 v[72:75], v225, s[52:55], s71 offen offset:2304 sc1
    buffer_load_dwordx4 v[76:79], v225, s[52:55], s71 offen offset:3456 sc1
    s_add_u32 s71, s32, 4608
    buffer_load_dwordx4 v[80:83], v225, s[52:55], s71 offen offset:0 sc1
    buffer_load_dwordx4 v[84:87], v225, s[52:55], s71 offen offset:1152 sc1
    buffer_load_dwordx4 v[88:91], v225, s[52:55], s71 offen offset:2304 sc1
    buffer_load_dwordx4 v[92:95], v225, s[52:55], s71 offen offset:3456 sc1
    s_add_u32 s71, s33, 9216
    buffer_load_dwordx4 v[96:99], v225, s[52:55], s71 offen offset:0 sc1
    buffer_load_dwordx4 v[100:103], v225, s[52:55], s71 offen offset:1152 sc1
    buffer_load_dwordx4 v[104:107], v225, s[52:55], s71 offen offset:2304 sc1
    buffer_load_dwordx4 v[108:111], v225, s[52:55], s71 offen offset:3456 sc1
    s_add_u32 s71, s33, 13824
    buffer_load_dwordx4 v[112:115], v225, s[52:55], s71 offen offset:0 sc1
    buffer_load_dwordx4 v[116:119], v225, s[52:55], s71 offen offset:1152 sc1
    buffer_load_dwordx4 v[120:123], v225, s[52:55], s71 offen offset:2304 sc1
    buffer_load_dwordx4 v[124:127], v225, s[52:55], s71 offen offset:3456 sc1
    buffer_load_dwordx4 v[232:235], v11, s[52:55], s25 offen offset:1024 sc1
    v_mov_b32 v3, 0
    s_waitcnt vmcnt(16)
    v_xor_b32 v64, s28, v64
    v_xor_b32 v65, s29, v65
    v_xor_b32 v66, s30, v66
    v_xor_b32 v67, s31, v67
    v_or3_b32 v3, v3, v64, v65
    v_or3_b32 v3, v3, v66, v67
    s_waitcnt vmcnt(15)
    v_xor_b32_e64 v68, s28, v68
    v_xor_b32 v69, s29, v69
    v_xor_b32 v70, s30, v70
    v_xor_b32 v71, s31, v71
    v_or3_b32 v3, v3, v68, v69
    v_or3_b32 v3, v3, v70, v71
    v_pk_add_f32 v[64:65], v[64:65], v[68:69]
    v_pk_add_f32 v[66:67], v[66:67], v[70:71]
    s_waitcnt vmcnt(14)
    v_xor_b32_e64 v72, s28, v72
    v_xor_b32 v73, s29, v73
    v_xor_b32 v74, s30, v74
    v_xor_b32 v75, s31, v75
    v_or3_b32 v3, v3, v72, v73
    v_or3_b32 v3, v3, v74, v75
    v_pk_add_f32 v[64:65], v[64:65], v[72:73]
    v_pk_add_f32 v[66:67], v[66:67], v[74:75]
    s_waitcnt vmcnt(13)
    v_xor_b32_e64 v76, s28, v76
    v_xor_b32 v77, s29, v77
    v_xor_b32 v78, s30, v78
    v_xor_b32 v79, s31, v79
    v_or3_b32 v3, v3, v76, v77
    v_or3_b32 v3, v3, v78, v79
    v_pk_add_f32 v[64:65], v[64:65], v[76:77]
    v_pk_add_f32 v[66:67], v[66:67], v[78:79]
    s_waitcnt vmcnt(12)
    v_xor_b32_e64 v80, s28, v80
    v_xor_b32 v81, s29, v81
    v_xor_b32 v82, s30, v82
    v_xor_b32 v83, s31, v83
    v_or3_b32 v3, v3, v80, v81
    v_or3_b32 v3, v3, v82, v83
    v_pk_add_f32 v[64:65], v[64:65], v[80:81]
    v_pk_add_f32 v[66:67], v[66:67], v[82:83]
    s_waitcnt vmcnt(11)
    v_xor_b32_e64 v84, s28, v84
    v_xor_b32 v85, s29, v85
    v_xor_b32 v86, s30, v86
    v_xor_b32 v87, s31, v87
    v_or3_b32 v3, v3, v84, v85
    v_or3_b32 v3, v3, v86, v87
    v_pk_add_f32 v[64:65], v[64:65], v[84:85]
    v_pk_add_f32 v[66:67], v[66:67], v[86:87]
    s_waitcnt vmcnt(10)
    v_xor_b32_e64 v88, s28, v88
    v_xor_b32 v89, s29, v89
    v_xor_b32 v90, s30, v90
    v_xor_b32 v91, s31, v91
    v_or3_b32 v3, v3, v88, v89
    v_or3_b32 v3, v3, v90, v91
    v_pk_add_f32 v[64:65], v[64:65], v[88:89]
    v_pk_add_f32 v[66:67], v[66:67], v[90:91]
    s_waitcnt vmcnt(9)
    v_xor_b32_e64 v92, s28, v92
    v_xor_b32 v93, s29, v93
    v_xor_b32 v94, s30, v94
    v_xor_b32 v95, s31, v95
    v_or3_b32 v3, v3, v92, v93
    v_or3_b32 v3, v3, v94, v95
    v_pk_add_f32 v[64:65], v[64:65], v[92:93]
    v_pk_add_f32 v[66:67], v[66:67], v[94:95]
    s_waitcnt vmcnt(8)
    s_load_dwordx4 s[44:47], s[40:41], 0 glc
    v_xor_b32_e64 v96, s28, v96
    v_xor_b32 v97, s29, v97
    v_xor_b32 v98, s30, v98
    v_xor_b32 v99, s31, v99
    v_or3_b32 v3, v3, v96, v97
    v_or3_b32 v3, v3, v98, v99
    v_pk_add_f32 v[64:65], v[64:65], v[96:97]
    v_pk_add_f32 v[66:67], v[66:67], v[98:99]
    s_waitcnt vmcnt(7)
    v_xor_b32_e64 v100, s28, v100
    v_xor_b32 v101, s29, v101
    v_xor_b32 v102, s30, v102
    v_xor_b32 v103, s31, v103
    v_or3_b32 v3, v3, v100, v101
    v_or3_b32 v3, v3, v102, v103
    v_pk_add_f32 v[64:65], v[64:65], v[100:101]
    v_pk_add_f32 v[66:67], v[66:67], v[102:103]
    s_waitcnt vmcnt(6)
    v_xor_b32_e64 v104, s28, v104
    v_xor_b32 v105, s29, v105
    v_xor_b32 v106, s30, v106
    v_xor_b32 v107, s31, v107
    v_or3_b32 v3, v3, v104, v105
    v_or3_b32 v3, v3, v106, v107
    v_pk_add_f32 v[64:65], v[64:65], v[104:105]
    v_pk_add_f32 v[66:67], v[66:67], v[106:107]
    s_waitcnt vmcnt(5)
    v_xor_b32_e64 v108, s28, v108
    v_xor_b32 v109, s29, v109
    v_xor_b32 v110, s30, v110
    v_xor_b32 v111, s31, v111
    v_or3_b32 v3, v3, v108, v109
    v_or3_b32 v3, v3, v110, v111
    v_pk_add_f32 v[64:65], v[64:65], v[108:109]
    v_pk_add_f32 v[66:67], v[66:67], v[110:111]
    s_waitcnt vmcnt(4)
    v_xor_b32_e64 v112, s28, v112
    v_xor_b32 v113, s29, v113
    v_xor_b32 v114, s30, v114
    v_xor_b32 v115, s31, v115
    v_or3_b32 v3, v3, v112, v113
    v_or3_b32 v3, v3, v114, v115
    v_pk_add_f32 v[64:65], v[64:65], v[112:113]
    v_pk_add_f32 v[66:67], v[66:67], v[114:115]
    s_waitcnt vmcnt(3)
    v_xor_b32_e64 v116, s28, v116
    v_xor_b32 v117, s29, v117
    v_xor_b32 v118, s30, v118
    v_xor_b32 v119, s31, v119
    v_or3_b32 v3, v3, v116, v117
    v_or3_b32 v3, v3, v118, v119
    v_pk_add_f32 v[64:65], v[64:65], v[116:117]
    v_pk_add_f32 v[66:67], v[66:67], v[118:119]
    s_waitcnt vmcnt(2)
    v_xor_b32_e64 v120, s28, v120
    v_xor_b32 v121, s29, v121
    v_xor_b32 v122, s30, v122
    v_xor_b32 v123, s31, v123
    v_or3_b32 v3, v3, v120, v121
    v_or3_b32 v3, v3, v122, v123
    v_pk_add_f32 v[64:65], v[64:65], v[120:121]
    v_pk_add_f32 v[66:67], v[66:67], v[122:123]
    s_waitcnt vmcnt(1)
    v_xor_b32_e64 v124, s28, v124
    v_xor_b32 v125, s29, v125
    v_xor_b32 v126, s30, v126
    v_xor_b32 v127, s31, v127
    v_or3_b32 v3, v3, v124, v125
    v_or3_b32 v3, v3, v126, v127
    v_pk_add_f32 v[64:65], v[64:65], v[124:125]
    v_pk_add_f32 v[66:67], v[66:67], v[126:127]
    s_waitcnt vmcnt(0)
    v_xor_b32 v232, s28, v232
    v_xor_b32 v233, s29, v233
    v_xor_b32 v234, s30, v234
    v_xor_b32 v235, s31, v235
    v_or3_b32 v3, v3, v232, v233
    v_or3_b32 v3, v3, v234, v235
    v_and_b32_e64 v3, v10, v3
    v_cmp_ne_u32 vcc, 0, v3
    v_add_f32_dpp v232, v232, v232 row_ror:1 row_mask:0xf bank_mask:0xf
    v_add_f32_dpp v233, v233, v233 row_ror:1 row_mask:0xf bank_mask:0xf
    v_add_f32_dpp v234, v234, v234 row_ror:1 row_mask:0xf bank_mask:0xf
    v_add_f32_dpp v235, v235, v235 row_ror:1 row_mask:0xf bank_mask:0xf
    v_add_f32_dpp v232, v232, v232 row_ror:2 row_mask:0xf bank_mask:0xf
    v_add_f32_dpp v233, v233, v233 row_ror:2 row_mask:0xf bank_mask:0xf
    v_add_f32_dpp v234, v234, v234 row_ror:2 row_mask:0xf bank_mask:0xf
    v_add_f32_dpp v235, v235, v235 row_ror:2 row_mask:0xf bank_mask:0xf
    v_add_f32_dpp v232, v232, v232 row_ror:4 row_mask:0xf bank_mask:0xf
    v_add_f32_dpp v233, v233, v233 row_ror:4 row_mask:0xf bank_mask:0xf
    v_add_f32_dpp v234, v234, v234 row_ror:4 row_mask:0xf bank_mask:0xf
    v_add_f32_dpp v235, v235, v235 row_ror:4 row_mask:0xf bank_mask:0xf
    v_add_f32_dpp v232, v232, v232 row_ror:8 row_mask:0xf bank_mask:0xf
    v_add_f32_dpp v233, v233, v233 row_ror:8 row_mask:0xf bank_mask:0xf
    v_add_f32_dpp v234, v234, v234 row_ror:8 row_mask:0xf bank_mask:0xf
    v_add_f32_dpp v235, v235, v235 row_ror:8 row_mask:0xf bank_mask:0xf
    s_cmp_lg_u64 vcc, 0
    s_cbranch_scc1 L_gretry_30
L_gdone_31:
    v_cvt_pk_bf16_f32 v236, v64, v65
    v_cvt_pk_bf16_f32 v237, v66, v67
    v_cvt_pk_bf16_f32 v238, v232, v233
    v_cvt_pk_bf16_f32 v239, v234, v235
    ds_write_b128 v6, v[236:239]
    ds_write_b32 v229, v2 offset:48
    s_waitcnt lgkmcnt(0)
    s_xor_b64 s[44:45], s[44:45], s[42:43]
    s_xor_b64 s[46:47], s[46:47], s[42:43]
    s_or_b64 s[44:45], s[44:45], s[46:47]
    s_cbranch_scc1 L_chkm_34
L_chkd_33:
    s_add_u32 s70, s16, 0
    buffer_load_dwordx4 v[80:83], v248, s[52:55], s70 offen offset:0 sc1
    buffer_load_dwordx4 v[84:87], v248, s[52:55], s70 offen offset:1024 sc1
    buffer_load_dwordx4 v[88:91], v249, s[52:55], s70 offen offset:0 sc1
    buffer_load_dwordx4 v[92:95], v249, s[52:55], s70 offen offset:1024 sc1
    buffer_load_dwordx4 v[96:99], v250, s[52:55], s70 offen offset:0 sc1
    buffer_load_dwordx4 v[100:103], v250, s[52:55], s70 offen offset:1024 sc1
    v_mfma_f32_16x16x16_bf16 v[20:23], v[238:239], v[48:49], 0
    v_mfma_f32_16x16x16_bf16 v[28:31], v[238:239], v[52:53], 0
    v_mfma_f32_16x16x16_bf16 v[68:71], v[238:239], v[56:57], 0
    v_mfma_f32_16x16x16_bf16 v[76:79], v[238:239], v[60:61], 0
    v_mfma_f32_16x16x16_bf16 v[16:19], v[236:237], v[48:49], 0
    v_mfma_f32_16x16x16_bf16 v[24:27], v[236:237], v[52:53], 0
    v_mfma_f32_16x16x16_bf16 v[64:67], v[236:237], v[56:57], 0
    v_mfma_f32_16x16x16_bf16 v[72:75], v[236:237], v[60:61], 0
    s_nop 0
    s_nop 0
    v_fmamk_f32 v20, v20, 0x3fb8aa3b, v230
    v_fmamk_f32 v28, v28, 0x3fb8aa3b, v230
    v_fmamk_f32 v68, v68, 0x3fb8aa3b, v230
    v_fmamk_f32 v76, v76, 0x3fb8aa3b, v230
    v_rcp_f32 v20, v20
    v_rcp_f32 v28, v28
    v_rcp_f32 v68, v68
    v_rcp_f32 v76, v76
    v_pk_mul_f32 v[16:17], v[16:17], v[20:21] op_sel_hi:[1,0]
    v_pk_mul_f32 v[18:19], v[18:19], v[20:21] op_sel_hi:[1,0]
    v_pk_mul_f32 v[24:25], v[24:25], v[28:29] op_sel_hi:[1,0]
    v_pk_mul_f32 v[26:27], v[26:27], v[28:29] op_sel_hi:[1,0]
    v_pk_mul_f32 v[64:65], v[64:65], v[68:69] op_sel_hi:[1,0]
    v_pk_mul_f32 v[66:67], v[66:67], v[68:69] op_sel_hi:[1,0]
    v_pk_mul_f32 v[72:73], v[72:73], v[76:77] op_sel_hi:[1,0]
    v_pk_mul_f32 v[74:75], v[74:75], v[76:77] op_sel_hi:[1,0]
    v_cvt_pk_bf16_f32 v48, v16, v17
    v_cvt_pk_bf16_f32 v49, v18, v19
    v_cvt_pk_bf16_f32 v52, v24, v25
    v_cvt_pk_bf16_f32 v53, v26, v27
    v_cvt_pk_bf16_f32 v56, v64, v65
    v_cvt_pk_bf16_f32 v57, v66, v67
    v_cvt_pk_bf16_f32 v60, v72, v73
    v_cvt_pk_bf16_f32 v61, v74, v75
    s_mov_b32 s79, 2000000
L_pair_35:
    ds_read_b32 v3, v9 offset:48
    ds_read_b128 v[240:243], v7
    s_waitcnt lgkmcnt(1)
    v_readfirstlane_b32 s75, v3
    s_nop 0
    s_cmp_eq_u32 s75, 0
    s_cbranch_scc1 L_pairm_36
L_paird_37:
    s_waitcnt lgkmcnt(0)
    s_load_dwordx4 s[60:63], s[40:41], 1024 glc
    v_mfma_f32_16x16x16_bf16 v[20:23], v[242:243], v[50:51], 0
    v_mfma_f32_16x16x16_bf16 v[28:31], v[242:243], v[54:55], 0
    v_mfma_f32_16x16x16_bf16 v[68:71], v[242:243], v[58:59], 0
    v_mfma_f32_16x16x16_bf16 v[76:79], v[242:243], v[62:63], 0
    v_mfma_f32_16x16x16_bf16 v[16:19], v[240:241], v[50:51], 0
    v_mfma_f32_16x16x16_bf16 v[24:27], v[240:241], v[54:55], 0
    v_mfma_f32_16x16x16_bf16 v[64:67], v[240:241], v[58:59], 0
    v_mfma_f32_16x16x16_bf16 v[72:75], v[240:241], v[62:63], 0
    s_nop 0
    s_nop 0
    v_fmamk_f32 v20, v20, 0x3fb8aa3b, v230
    v_fmamk_f32 v28, v28, 0x3fb8aa3b, v230
    v_fmamk_f32 v68, v68, 0x3fb8aa3b, v230
    v_fmamk_f32 v76, v76, 0x3fb8aa3b, v230
    v_rcp_f32 v20, v20
    v_rcp_f32 v28, v28
    v_rcp_f32 v68, v68
    v_rcp_f32 v76, v76
    v_pk_mul_f32 v[16:17], v[16:17], v[20:21] op_sel_hi:[1,0]
    v_pk_mul_f32 v[18:19], v[18:19], v[20:21] op_sel_hi:[1,0]
    v_pk_mul_f32 v[24:25], v[24:25], v[28:29] op_sel_hi:[1,0]
    v_pk_mul_f32 v[26:27], v[26:27], v[28:29] op_sel_hi:[1,0]
    v_pk_mul_f32 v[64:65], v[64:65], v[68:69] op_sel_hi:[1,0]
    v_pk_mul_f32 v[66:67], v[66:67], v[68:69] op_sel_hi:[1,0]
    v_pk_mul_f32 v[72:73], v[72:73], v[76:77] op_sel_hi:[1,0]
    v_pk_mul_f32 v[74:75], v[74:75], v[76:77] op_sel_hi:[1,0]
    v_cvt_pk_bf16_f32 v50, v16, v17
    v_cvt_pk_bf16_f32 v51, v18, v19
    buffer_store_dwordx4 v[48:51], v225, s[52:55], s76 offen sc1
    v_cvt_pk_bf16_f32 v54, v24, v25
    v_cvt_pk_bf16_f32 v55, v26, v27
    buffer_store_dwordx4 v[52:55], v226, s[52:55], s76 offen sc1
    v_cvt_pk_bf16_f32 v58, v64, v65
    v_cvt_pk_bf16_f32 v59, v66, v67
    buffer_store_dwordx4 v[56:59], v225, s[52:55], s77 offen sc1
    v_cvt_pk_bf16_f32 v62, v72, v73
    v_cvt_pk_bf16_f32 v63, v74, v75
    buffer_store_dwordx4 v[60:63], v226, s[52:55], s77 offen sc1
L_p2:
    s_waitcnt vmcnt(6)
    v_permlane16_swap_b32 v40, v42
    v_permlane16_swap_b32 v41, v43
    v_permlane16_swap_b32 v44, v46
    v_permlane16_swap_b32 v45, v47
    v_mfma_f32_16x16x32_bf16 v[16:19], v[128:131], v[80:83], 0
    v_lshlrev_b32 v64, 16, v40
    v_and_b32 v65, s23, v40
    v_lshlrev_b32 v66, 16, v41
    v_mfma_f32_16x16x32_bf16 v[16:19], v[132:135], v[84:87], v[16:19]
    v_and_b32 v67, s23, v41
    v_lshlrev_b32 v68, 16, v42
    v_and_b32 v69, s23, v42
    v_mfma_f32_16x16x32_bf16 v[20:23], v[136:139], v[80:83], 0
    v_lshlrev_b32 v70, 16, v43
    v_and_b32 v71, s23, v43
    v_lshlrev_b32 v72, 16, v44
    v_mfma_f32_16x16x32_bf16 v[20:23], v[140:143], v[84:87], v[20:23]
    v_and_b32 v73, s23, v44
    v_lshlrev_b32 v74, 16, v45
    v_and_b32 v75, s23, v45
    v_mfma_f32_16x16x32_bf16 v[24:27], v[144:147], v[80:83], 0
    v_lshlrev_b32 v76, 16, v46
    v_and_b32 v77, s23, v46
    v_lshlrev_b32 v78, 16, v47
    v_mfma_f32_16x16x32_bf16 v[24:27], v[148:151], v[84:87], v[24:27]
    v_and_b32_e64 v79, s23, v47
    buffer_load_dwordx4 v[104:107], v251, s[52:55], s70 offen offset:0 sc1
    buffer_load_dwordx4 v[108:111], v251, s[52:55], s70 offen offset:1024 sc1
    v_mfma_f32_16x16x32_bf16 v[28:31], v[152:155], v[80:83], 0
    s_add_u32 s70, s16, 8192
    buffer_load_dwordx4 v[112:115], v248, s[52:55], s70 offen offset:0 sc1
    v_mfma_f32_16x16x32_bf16 v[28:31], v[156:159], v[84:87], v[28:31]
    buffer_load_dwordx4 v[116:119], v248, s[52:55], s70 offen offset:1024 sc1
    s_waitcnt vmcnt(8)
    v_mfma_f32_16x16x32_bf16 v[32:35], v[128:131], v[88:91], 0
    buffer_load_dwordx4 v[120:123], v249, s[52:55], s70 offen offset:0 sc1
    v_mfma_f32_16x16x32_bf16 v[32:35], v[132:135], v[92:95], v[32:35]
    buffer_load_dwordx4 v[124:127], v249, s[52:55], s70 offen offset:1024 sc1
    v_mfma_f32_16x16x32_bf16 v[36:39], v[136:139], v[88:91], 0
    v_mfma_f32_16x16x32_bf16 v[36:39], v[140:143], v[92:95], v[36:39]
    buffer_load_dwordx4 v[80:83], v250, s[52:55], s70 offen offset:0 sc1
    v_mfma_f32_16x16x32_bf16 v[40:43], v[144:147], v[88:91], 0
    buffer_load_dwordx4 v[84:87], v250, s[52:55], s70 offen offset:1024 sc1
    v_mfma_f32_16x16x32_bf16 v[40:43], v[148:151], v[92:95], v[40:43]
    v_mfma_f32_16x16x32_bf16 v[44:47], v[152:155], v[88:91], 0
    v_mfma_f32_16x16x32_bf16 v[44:47], v[156:159], v[92:95], v[44:47]
    s_waitcnt vmcnt(10) lgkmcnt(0)
    v_mfma_f32_16x16x32_bf16 v[48:51], v[128:131], v[96:99], 0
    s_xor_b64 s[60:61], s[60:61], s[42:43]
    s_xor_b64 s[62:63], s[62:63], s[42:43]
    v_mfma_f32_16x16x32_bf16 v[48:51], v[132:135], v[100:103], v[48:51]
    s_or_b64 s[60:61], s[60:61], s[62:63]
    s_cbranch_scc1 L_chkm_40
L_chkd_39:
    v_mfma_f32_16x16x32_bf16 v[52:55], v[136:139], v[96:99], 0
    buffer_load_dwordx4 v[88:91], v251, s[52:55], s70 offen offset:0 sc1
    v_mfma_f32_16x16x32_bf16 v[52:55], v[140:143], v[100:103], v[52:55]
    buffer_load_dwordx4 v[92:95], v251, s[52:55], s70 offen offset:1024 sc1
    v_mfma_f32_16x16x32_bf16 v[56:59], v[144:147], v[96:99], 0
    v_mfma_f32_16x16x32_bf16 v[56:59], v[148:151], v[100:103], v[56:59]
    s_add_u32 s70, s16, 2048
    v_mfma_f32_16x16x32_bf16 v[60:63], v[152:155], v[96:99], 0
    buffer_load_dwordx4 v[96:99], v248, s[52:55], s70 offen offset:0 sc1
    v_mfma_f32_16x16x32_bf16 v[60:63], v[156:159], v[100:103], v[60:63]
    buffer_load_dwordx4 v[100:103], v248, s[52:55], s70 offen offset:1024 sc1
    s_waitcnt vmcnt(10)
    s_atomic_swap s68, s[66:67], 2048
    v_mfma_f32_16x16x32_bf16 v[64:67], v[128:131], v[104:107], v[64:67]
    v_mfma_f32_16x16x32_bf16 v[64:67], v[132:135], v[108:111], v[64:67]
    v_mfma_f32_16x16x32_bf16 v[68:71], v[136:139], v[104:107], v[68:71]
    v_mfma_f32_16x16x32_bf16 v[68:71], v[140:143], v[108:111], v[68:71]
    v_mfma_f32_16x16x32_bf16 v[72:75], v[144:147], v[104:107], v[72:75]
    v_mfma_f32_16x16x32_bf16 v[72:75], v[148:151], v[108:111], v[72:75]
    v_mfma_f32_16x16x32_bf16 v[76:79], v[152:155], v[104:107], v[76:79]
    buffer_load_dwordx4 v[104:107], v249, s[52:55], s70 offen offset:0 sc1
    v_mfma_f32_16x16x32_bf16 v[76:79], v[156:159], v[108:111], v[76:79]
    buffer_load_dwordx4 v[108:111], v249, s[52:55], s70 offen offset:1024 sc1
    s_waitcnt vmcnt(10)
    v_mfma_f32_16x16x32_bf16 v[16:19], v[160:163], v[112:115], v[16:19]
    ds_read_b64_tr_b16 v[128:129], v244 offset:32768
    v_mfma_f32_16x16x32_bf16 v[16:19], v[164:167], v[116:119], v[16:19]
    ds_read_b64_tr_b16 v[130:131], v244 offset:34816
    v_mfma_f32_16x16x32_bf16 v[20:23], v[168:171], v[112:115], v[20:23]
    ds_read_b64_tr_b16 v[132:133], v244 offset:36864
    v_mfma_f32_16x16x32_bf16 v[20:23], v[172:175], v[116:119], v[20:23]
    ds_read_b64_tr_b16 v[134:135], v244 offset:38912
    v_mfma_f32_16x16x32_bf16 v[24:27], v[176:179], v[112:115], v[24:27]
    v_mfma_f32_16x16x32_bf16 v[24:27], v[180:183], v[116:119], v[24:27]
    v_mfma_f32_16x16x32_bf16 v[28:31], v[184:187], v[112:115], v[28:31]
    buffer_load_dwordx4 v[112:115], v250, s[52:55], s70 offen offset:0 sc1
    v_mfma_f32_16x16x32_bf16 v[28:31], v[188:191], v[116:119], v[28:31]
    buffer_load_dwordx4 v[116:119], v250, s[52:55], s70 offen offset:1024 sc1
    s_waitcnt vmcnt(10)
    v_mfma_f32_16x16x32_bf16 v[32:35], v[160:163], v[120:123], v[32:35]
    ds_read_b64_tr_b16 v[136:137], v245 offset:32768
    v_mfma_f32_16x16x32_bf16 v[32:35], v[164:167], v[124:127], v[32:35]
    ds_read_b64_tr_b16 v[138:139], v245 offset:34816
    v_mfma_f32_16x16x32_bf16 v[36:39], v[168:171], v[120:123], v[36:39]
    ds_read_b64_tr_b16 v[140:141], v245 offset:36864
    v_mfma_f32_16x16x32_bf16 v[36:39], v[172:175], v[124:127], v[36:39]
    ds_read_b64_tr_b16 v[142:143], v245 offset:38912
    v_mfma_f32_16x16x32_bf16 v[40:43], v[176:179], v[120:123], v[40:43]
    s_load_dwordx4 s[44:47], s[40:41], 4096 glc
    v_mfma_f32_16x16x32_bf16 v[40:43], v[180:183], v[124:127], v[40:43]
    v_mfma_f32_16x16x32_bf16 v[44:47], v[184:187], v[120:123], v[44:47]
    buffer_load_dwordx4 v[120:123], v251, s[52:55], s70 offen offset:0 sc1
    v_mfma_f32_16x16x32_bf16 v[44:47], v[188:191], v[124:127], v[44:47]
    buffer_load_dwordx4 v[124:127], v251, s[52:55], s70 offen offset:1024 sc1
    s_waitcnt vmcnt(10)
    v_mfma_f32_16x16x32_bf16 v[48:51], v[160:163], v[80:83], v[48:51]
    ds_read_b64_tr_b16 v[144:145], v246 offset:32768
    v_mfma_f32_16x16x32_bf16 v[48:51], v[164:167], v[84:87], v[48:51]
    ds_read_b64_tr_b16 v[146:147], v246 offset:34816
    v_mfma_f32_16x16x32_bf16 v[52:55], v[168:171], v[80:83], v[52:55]
    ds_read_b64_tr_b16 v[148:149], v246 offset:36864
    v_mfma_f32_16x16x32_bf16 v[52:55], v[172:175], v[84:87], v[52:55]
    ds_read_b64_tr_b16 v[150:151], v246 offset:38912
    v_mfma_f32_16x16x32_bf16 v[56:59], v[176:179], v[80:83], v[56:59]
    s_add_u32 s70, s16, 10240
    v_mfma_f32_16x16x32_bf16 v[56:59], v[180:183], v[84:87], v[56:59]
    v_mfma_f32_16x16x32_bf16 v[60:63], v[184:187], v[80:83], v[60:63]
    buffer_load_dwordx4 v[80:83], v248, s[52:55], s70 offen offset:0 sc1
    v_mfma_f32_16x16x32_bf16 v[60:63], v[188:191], v[84:87], v[60:63]
    buffer_load_dwordx4 v[84:87], v248, s[52:55], s70 offen offset:1024 sc1
    s_waitcnt vmcnt(10)
    v_mfma_f32_16x16x32_bf16 v[64:67], v[160:163], v[88:91], v[64:67]
    ds_read_b64_tr_b16 v[152:153], v247 offset:32768
    v_mfma_f32_16x16x32_bf16 v[64:67], v[164:167], v[92:95], v[64:67]
    ds_read_b64_tr_b16 v[154:155], v247 offset:34816
    v_mfma_f32_16x16x32_bf16 v[68:71], v[168:171], v[88:91], v[68:71]
    ds_read_b64_tr_b16 v[156:157], v247 offset:36864
    v_mfma_f32_16x16x32_bf16 v[68:71], v[172:175], v[92:95], v[68:71]
    ds_read_b64_tr_b16 v[158:159], v247 offset:38912
    v_mfma_f32_16x16x32_bf16 v[72:75], v[176:179], v[88:91], v[72:75]
    v_mfma_f32_16x16x32_bf16 v[72:75], v[180:183], v[92:95], v[72:75]
    v_mfma_f32_16x16x32_bf16 v[76:79], v[184:187], v[88:91], v[76:79]
    buffer_load_dwordx4 v[88:91], v249, s[52:55], s70 offen offset:0 sc1
    v_mfma_f32_16x16x32_bf16 v[76:79], v[188:191], v[92:95], v[76:79]
    buffer_load_dwordx4 v[92:95], v249, s[52:55], s70 offen offset:1024 sc1
    s_waitcnt vmcnt(10)
    v_mfma_f32_16x16x32_bf16 v[16:19], v[192:195], v[96:99], v[16:19]
    v_mfma_f32_16x16x32_bf16 v[16:19], v[196:199], v[100:103], v[16:19]
    v_mfma_f32_16x16x32_bf16 v[20:23], v[200:203], v[96:99], v[20:23]
    v_mfma_f32_16x16x32_bf16 v[20:23], v[204:207], v[100:103], v[20:23]
    v_mfma_f32_16x16x32_bf16 v[24:27], v[208:211], v[96:99], v[24:27]
    v_mfma_f32_16x16x32_bf16 v[24:27], v[212:215], v[100:103], v[24:27]
    v_mfma_f32_16x16x32_bf16 v[28:31], v[216:219], v[96:99], v[28:31]
    buffer_load_dwordx4 v[96:99], v250, s[52:55], s70 offen offset:0 sc1
    v_mfma_f32_16x16x32_bf16 v[28:31], v[220:223], v[100:103], v[28:31]
    buffer_load_dwordx4 v[100:103], v250, s[52:55], s70 offen offset:1024 sc1
    s_waitcnt vmcnt(10)
    v_mfma_f32_16x16x32_bf16 v[32:35], v[192:195], v[104:107], v[32:35]
    v_mfma_f32_16x16x32_bf16 v[32:35], v[196:199], v[108:111], v[32:35]
    v_mfma_f32_16x16x32_bf16 v[36:39], v[200:203], v[104:107], v[36:39]
    v_mfma_f32_16x16x32_bf16 v[36:39], v[204:207], v[108:111], v[36:39]
    v_mfma_f32_16x16x32_bf16 v[40:43], v[208:211], v[104:107], v[40:43]
    v_mfma_f32_16x16x32_bf16 v[40:43], v[212:215], v[108:111], v[40:43]
    v_mfma_f32_16x16x32_bf16 v[44:47], v[216:219], v[104:107], v[44:47]
    buffer_load_dwordx4 v[104:107], v251, s[52:55], s70 offen offset:0 sc1
    v_mfma_f32_16x16x32_bf16 v[44:47], v[220:223], v[108:111], v[44:47]
    buffer_load_dwordx4 v[108:111], v251, s[52:55], s70 offen offset:1024 sc1
    s_waitcnt vmcnt(10) lgkmcnt(0)
    s_barrier
    v_mfma_f32_16x16x32_bf16 v[48:51], v[192:195], v[112:115], v[48:51]
    s_xor_b64 s[44:45], s[44:45], s[42:43]
    s_xor_b64 s[46:47], s[46:47], s[42:43]
    s_or_b64 s[44:45], s[44:45], s[46:47]
    v_mfma_f32_16x16x32_bf16 v[48:51], v[196:199], v[116:119], v[48:51]
    s_cbranch_scc1 L_chkm_43
L_chkd_42:
    ds_read_b64_tr_b16 v[160:161], v252 offset:32768
    v_mfma_f32_16x16x32_bf16 v[52:55], v[200:203], v[112:115], v[52:55]
    ds_read_b64_tr_b16 v[162:163], v252 offset:34816
    ds_read_b64_tr_b16 v[164:165], v252 offset:36864
    v_mfma_f32_16x16x32_bf16 v[52:55], v[204:207], v[116:119], v[52:55]
    ds_read_b64_tr_b16 v[166:167], v252 offset:38912
    ds_read_b64_tr_b16 v[168:169], v253 offset:32768
    v_mfma_f32_16x16x32_bf16 v[56:59], v[208:211], v[112:115], v[56:59]
    ds_read_b64_tr_b16 v[170:171], v253 offset:34816
    ds_read_b64_tr_b16 v[172:173], v253 offset:36864
    v_mfma_f32_16x16x32_bf16 v[56:59], v[212:215], v[116:119], v[56:59]
    ds_read_b64_tr_b16 v[174:175], v253 offset:38912
    s_add_u32 s70, s16, 4096
    v_mfma_f32_16x16x32_bf16 v[60:63], v[216:219], v[112:115], v[60:63]
    buffer_load_dwordx4 v[112:115], v248, s[52:55], s70 offen offset:0 sc1
    v_mfma_f32_16x16x32_bf16 v[60:63], v[220:223], v[116:119], v[60:63]
    buffer_load_dwordx4 v[116:119], v248, s[52:55], s70 offen offset:1024 sc1
    s_waitcnt vmcnt(10)
    v_mfma_f32_16x16x32_bf16 v[64:67], v[192:195], v[120:123], v[64:67]
    ds_read_b64_tr_b16 v[176:177], v254 offset:32768
    ds_read_b64_tr_b16 v[178:179], v254 offset:34816
    v_mfma_f32_16x16x32_bf16 v[64:67], v[196:199], v[124:127], v[64:67]
    ds_read_b64_tr_b16 v[180:181], v254 offset:36864
    ds_read_b64_tr_b16 v[182:183], v254 offset:38912
    v_mfma_f32_16x16x32_bf16 v[68:71], v[200:203], v[120:123], v[68:71]
    ds_read_b64_tr_b16 v[184:185], v255 offset:32768
    v_mfma_f32_16x16x32_bf16 v[68:71], v[204:207], v[124:127], v[68:71]
    ds_read_b64_tr_b16 v[186:187], v255 offset:34816
    v_mfma_f32_16x16x32_bf16 v[72:75], v[208:211], v[120:123], v[72:75]
    ds_read_b64_tr_b16 v[188:189], v255 offset:36864
    v_mfma_f32_16x16x32_bf16 v[72:75], v[212:215], v[124:127], v[72:75]
    ds_read_b64_tr_b16 v[190:191], v255 offset:38912
    v_mfma_f32_16x16x32_bf16 v[76:79], v[216:219], v[120:123], v[76:79]
    buffer_load_dwordx4 v[120:123], v249, s[52:55], s70 offen offset:0 sc1
    v_mfma_f32_16x16x32_bf16 v[76:79], v[220:223], v[124:127], v[76:79]
    buffer_load_dwordx4 v[124:127], v249, s[52:55], s70 offen offset:1024 sc1
    s_waitcnt vmcnt(10) lgkmcnt(15)
    v_mfma_f32_16x16x32_bf16 v[16:19], v[128:131], v[80:83], v[16:19]
    ds_read_b64_tr_b16 v[192:193], v244 offset:0
    v_mfma_f32_16x16x32_bf16 v[16:19], v[132:135], v[84:87], v[16:19]
    ds_read_b64_tr_b16 v[194:195], v244 offset:2048
    v_mfma_f32_16x16x32_bf16 v[20:23], v[136:139], v[80:83], v[20:23]
    ds_read_b64_tr_b16 v[196:197], v244 offset:4096
    v_mfma_f32_16x16x32_bf16 v[20:23], v[140:143], v[84:87], v[20:23]
    ds_read_b64_tr_b16 v[198:199], v244 offset:6144
    v_mfma_f32_16x16x32_bf16 v[24:27], v[144:147], v[80:83], v[24:27]
    v_mfma_f32_16x16x32_bf16 v[24:27], v[148:151], v[84:87], v[24:27]
    v_mfma_f32_16x16x32_bf16 v[28:31], v[152:155], v[80:83], v[28:31]
    buffer_load_dwordx4 v[80:83], v250, s[52:55], s70 offen offset:0 sc1
    v_mfma_f32_16x16x32_bf16 v[28:31], v[156:159], v[84:87], v[28:31]
    buffer_load_dwordx4 v[84:87], v250, s[52:55], s70 offen offset:1024 sc1
    s_waitcnt vmcnt(10) lgkmcnt(4)
    s_barrier
    v_mfma_f32_16x16x32_bf16 v[32:35], v[128:131], v[88:91], v[32:35]
    ds_read_b64_tr_b16 v[200:201], v245 offset:0
    v_mfma_f32_16x16x32_bf16 v[32:35], v[132:135], v[92:95], v[32:35]
    ds_read_b64_tr_b16 v[202:203], v245 offset:2048
    v_mfma_f32_16x16x32_bf16 v[36:39], v[136:139], v[88:91], v[36:39]
    ds_read_b64_tr_b16 v[204:205], v245 offset:4096
    v_mfma_f32_16x16x32_bf16 v[36:39], v[140:143], v[92:95], v[36:39]
    ds_read_b64_tr_b16 v[206:207], v245 offset:6144
    v_mfma_f32_16x16x32_bf16 v[40:43], v[144:147], v[88:91], v[40:43]
    s_load_dwordx4 s[60:63], s[40:41], 2048 glc
    v_mfma_f32_16x16x32_bf16 v[40:43], v[148:151], v[92:95], v[40:43]
    v_mfma_f32_16x16x32_bf16 v[44:47], v[152:155], v[88:91], v[44:47]
    buffer_load_dwordx4 v[88:91], v251, s[52:55], s70 offen offset:0 sc1
    v_mfma_f32_16x16x32_bf16 v[44:47], v[156:159], v[92:95], v[44:47]
    buffer_load_dwordx4 v[92:95], v251, s[52:55], s70 offen offset:1024 sc1
    s_waitcnt vmcnt(10)
    v_mfma_f32_16x16x32_bf16 v[48:51], v[128:131], v[96:99], v[48:51]
    ds_read_b64_tr_b16 v[208:209], v246 offset:0
    v_mfma_f32_16x16x32_bf16 v[48:51], v[132:135], v[100:103], v[48:51]
    ds_read_b64_tr_b16 v[210:211], v246 offset:2048
    v_mfma_f32_16x16x32_bf16 v[52:55], v[136:139], v[96:99], v[52:55]
    ds_read_b64_tr_b16 v[212:213], v246 offset:4096
    v_mfma_f32_16x16x32_bf16 v[52:55], v[140:143], v[100:103], v[52:55]
    ds_read_b64_tr_b16 v[214:215], v246 offset:6144
    v_mfma_f32_16x16x32_bf16 v[56:59], v[144:147], v[96:99], v[56:59]
    s_add_u32 s70, s16, 12288
    v_mfma_f32_16x16x32_bf16 v[56:59], v[148:151], v[100:103], v[56:59]
    v_mfma_f32_16x16x32_bf16 v[60:63], v[152:155], v[96:99], v[60:63]
    buffer_load_dwordx4 v[96:99], v248, s[52:55], s70 offen offset:0 sc1
    v_mfma_f32_16x16x32_bf16 v[60:63], v[156:159], v[100:103], v[60:63]
    buffer_load_dwordx4 v[100:103], v248, s[52:55], s70 offen offset:1024 sc1
    s_waitcnt vmcnt(10)
    v_mfma_f32_16x16x32_bf16 v[64:67], v[128:131], v[104:107], v[64:67]
    ds_read_b64_tr_b16 v[216:217], v247 offset:0
    v_mfma_f32_16x16x32_bf16 v[64:67], v[132:135], v[108:111], v[64:67]
    ds_read_b64_tr_b16 v[218:219], v247 offset:2048
    v_mfma_f32_16x16x32_bf16 v[68:71], v[136:139], v[104:107], v[68:71]
    ds_read_b64_tr_b16 v[220:221], v247 offset:4096
    v_mfma_f32_16x16x32_bf16 v[68:71], v[140:143], v[108:111], v[68:71]
    ds_read_b64_tr_b16 v[222:223], v247 offset:6144
    v_mfma_f32_16x16x32_bf16 v[72:75], v[144:147], v[104:107], v[72:75]
    v_mfma_f32_16x16x32_bf16 v[72:75], v[148:151], v[108:111], v[72:75]
    v_mfma_f32_16x16x32_bf16 v[76:79], v[152:155], v[104:107], v[76:79]
    buffer_load_dwordx4 v[104:107], v249, s[52:55], s70 offen offset:0 sc1
    v_mfma_f32_16x16x32_bf16 v[76:79], v[156:159], v[108:111], v[76:79]
    buffer_load_dwordx4 v[108:111], v249, s[52:55], s70 offen offset:1024 sc1
    s_waitcnt vmcnt(10) lgkmcnt(15)
    v_mfma_f32_16x16x32_bf16 v[16:19], v[160:163], v[112:115], v[16:19]
    s_load_dwordx4 s[44:47], s[40:41], 3072 glc
    v_mfma_f32_16x16x32_bf16 v[16:19], v[164:167], v[116:119], v[16:19]
    v_mfma_f32_16x16x32_bf16 v[20:23], v[168:171], v[112:115], v[20:23]
    v_mfma_f32_16x16x32_bf16 v[20:23], v[172:175], v[116:119], v[20:23]
    v_mfma_f32_16x16x32_bf16 v[24:27], v[176:179], v[112:115], v[24:27]
    v_mfma_f32_16x16x32_bf16 v[24:27], v[180:183], v[116:119], v[24:27]
    v_mfma_f32_16x16x32_bf16 v[28:31], v[184:187], v[112:115], v[28:31]
    buffer_load_dwordx4 v[112:115], v250, s[52:55], s70 offen offset:0 sc1
    v_mfma_f32_16x16x32_bf16 v[28:31], v[188:191], v[116:119], v[28:31]
    buffer_load_dwordx4 v[116:119], v250, s[52:55], s70 offen offset:1024 sc1
    s_waitcnt vmcnt(10)
    v_mfma_f32_16x16x32_bf16 v[32:35], v[160:163], v[120:123], v[32:35]
    v_mfma_f32_16x16x32_bf16 v[32:35], v[164:167], v[124:127], v[32:35]
    v_mfma_f32_16x16x32_bf16 v[36:39], v[168:171], v[120:123], v[36:39]
    v_mfma_f32_16x16x32_bf16 v[36:39], v[172:175], v[124:127], v[36:39]
    v_mfma_f32_16x16x32_bf16 v[40:43], v[176:179], v[120:123], v[40:43]
    v_mfma_f32_16x16x32_bf16 v[40:43], v[180:183], v[124:127], v[40:43]
    v_mfma_f32_16x16x32_bf16 v[44:47], v[184:187], v[120:123], v[44:47]
    buffer_load_dwordx4 v[120:123], v251, s[52:55], s70 offen offset:0 sc1
    v_mfma_f32_16x16x32_bf16 v[44:47], v[188:191], v[124:127], v[44:47]
    buffer_load_dwordx4 v[124:127], v251, s[52:55], s70 offen offset:1024 sc1
    s_waitcnt vmcnt(10) lgkmcnt(0)
    v_mfma_f32_16x16x32_bf16 v[48:51], v[160:163], v[80:83], v[48:51]
    s_xor_b64 s[60:61], s[60:61], s[42:43]
    s_xor_b64 s[62:63], s[62:63], s[42:43]
    s_or_b64 s[60:61], s[60:61], s[62:63]
    v_mfma_f32_16x16x32_bf16 v[48:51], v[164:167], v[84:87], v[48:51]
    s_cbranch_scc1 L_chkm_46
L_chkd_45:
    ds_read_b64_tr_b16 v[128:129], v252 offset:0
    v_mfma_f32_16x16x32_bf16 v[52:55], v[168:171], v[80:83], v[52:55]
    ds_read_b64_tr_b16 v[130:131], v252 offset:2048
    ds_read_b64_tr_b16 v[132:133], v252 offset:4096
    v_mfma_f32_16x16x32_bf16 v[52:55], v[172:175], v[84:87], v[52:55]
    ds_read_b64_tr_b16 v[134:135], v252 offset:6144
    ds_read_b64_tr_b16 v[136:137], v253 offset:0
    v_mfma_f32_16x16x32_bf16 v[56:59], v[176:179], v[80:83], v[56:59]
    ds_read_b64_tr_b16 v[138:139], v253 offset:2048
    ds_read_b64_tr_b16 v[140:141], v253 offset:4096
    v_mfma_f32_16x16x32_bf16 v[56:59], v[180:183], v[84:87], v[56:59]
    ds_read_b64_tr_b16 v[142:143], v253 offset:6144
    s_add_u32 s70, s16, 6144
    v_mfma_f32_16x16x32_bf16 v[60:63], v[184:187], v[80:83], v[60:63]
    buffer_load_dwordx4 v[80:83], v248, s[52:55], s70 offen offset:0 sc1
    v_mfma_f32_16x16x32_bf16 v[60:63], v[188:191], v[84:87], v[60:63]
    buffer_load_dwordx4 v[84:87], v248, s[52:55], s70 offen offset:1024 sc1
    s_waitcnt vmcnt(10)
    v_mfma_f32_16x16x32_bf16 v[64:67], v[160:163], v[88:91], v[64:67]
    ds_read_b64_tr_b16 v[144:145], v254 offset:0
    ds_read_b64_tr_b16 v[146:147], v254 offset:2048
    v_mfma_f32_16x16x32_bf16 v[64:67], v[164:167], v[92:95], v[64:67]
    ds_read_b64_tr_b16 v[148:149], v254 offset:4096
    ds_read_b64_tr_b16 v[150:151], v254 offset:6144
    v_mfma_f32_16x16x32_bf16 v[68:71], v[168:171], v[88:91], v[68:71]
    ds_read_b64_tr_b16 v[152:153], v255 offset:0
    v_mfma_f32_16x16x32_bf16 v[68:71], v[172:175], v[92:95], v[68:71]
    ds_read_b64_tr_b16 v[154:155], v255 offset:2048
    v_mfma_f32_16x16x32_bf16 v[72:75], v[176:179], v[88:91], v[72:75]
    ds_read_b64_tr_b16 v[156:157], v255 offset:4096
    v_mfma_f32_16x16x32_bf16 v[72:75], v[180:183], v[92:95], v[72:75]
    ds_read_b64_tr_b16 v[158:159], v255 offset:6144
    v_mfma_f32_16x16x32_bf16 v[76:79], v[184:187], v[88:91], v[76:79]
    buffer_load_dwordx4 v[88:91], v249, s[52:55], s70 offen offset:0 sc1
    v_mfma_f32_16x16x32_bf16 v[76:79], v[188:191], v[92:95], v[76:79]
    buffer_load_dwordx4 v[92:95], v249, s[52:55], s70 offen offset:1024 sc1
    s_waitcnt vmcnt(10) lgkmcnt(15)
    v_mfma_f32_16x16x32_bf16 v[16:19], v[192:195], v[96:99], v[16:19]
    v_mfma_f32_16x16x32_bf16 v[16:19], v[196:199], v[100:103], v[16:19]
    v_mfma_f32_16x16x32_bf16 v[20:23], v[200:203], v[96:99], v[20:23]
    v_mfma_f32_16x16x32_bf16 v[20:23], v[204:207], v[100:103], v[20:23]
    v_mfma_f32_16x16x32_bf16 v[24:27], v[208:211], v[96:99], v[24:27]
    v_mfma_f32_16x16x32_bf16 v[24:27], v[212:215], v[100:103], v[24:27]
    v_mfma_f32_16x16x32_bf16 v[28:31], v[216:219], v[96:99], v[28:31]
    buffer_load_dwordx4 v[96:99], v250, s[52:55], s70 offen offset:0 sc1
    v_mfma_f32_16x16x32_bf16 v[28:31], v[220:223], v[100:103], v[28:31]
    buffer_load_dwordx4 v[100:103], v250, s[52:55], s70 offen offset:1024 sc1
    s_waitcnt vmcnt(10)
    v_mfma_f32_16x16x32_bf16 v[32:35], v[192:195], v[104:107], v[32:35]
    v_mfma_f32_16x16x32_bf16 v[32:35], v[196:199], v[108:111], v[32:35]
    v_mfma_f32_16x16x32_bf16 v[36:39], v[200:203], v[104:107], v[36:39]
    v_mfma_f32_16x16x32_bf16 v[36:39], v[204:207], v[108:111], v[36:39]
    v_mfma_f32_16x16x32_bf16 v[40:43], v[208:211], v[104:107], v[40:43]
    v_mfma_f32_16x16x32_bf16 v[40:43], v[212:215], v[108:111], v[40:43]
    v_mfma_f32_16x16x32_bf16 v[44:47], v[216:219], v[104:107], v[44:47]
    buffer_load_dwordx4 v[104:107], v251, s[52:55], s70 offen offset:0 sc1
    v_mfma_f32_16x16x32_bf16 v[44:47], v[220:223], v[108:111], v[44:47]
    buffer_load_dwordx4 v[108:111], v251, s[52:55], s70 offen offset:1024 sc1
    s_waitcnt vmcnt(10) lgkmcnt(0)
    s_barrier
    v_mfma_f32_16x16x32_bf16 v[48:51], v[192:195], v[112:115], v[48:51]
    s_xor_b64 s[44:45], s[44:45], s[42:43]
    s_xor_b64 s[46:47], s[46:47], s[42:43]
    s_or_b64 s[44:45], s[44:45], s[46:47]
    v_mfma_f32_16x16x32_bf16 v[48:51], v[196:199], v[116:119], v[48:51]
    s_cbranch_scc1 L_chkm_49
L_chkd_48:
    s_cmp_eq_u32 s19, 0
    s_cbranch_scc1 L_epoch_50
L_epochd_51:
    v_mfma_f32_16x16x32_bf16 v[52:55], v[200:203], v[112:115], v[52:55]
    ds_read_b64_tr_b16 v[160:161], v244 offset:32768
    ds_read_b64_tr_b16 v[162:163], v244 offset:34816
    v_mfma_f32_16x16x32_bf16 v[52:55], v[204:207], v[116:119], v[52:55]
    ds_read_b64_tr_b16 v[164:165], v244 offset:36864
    ds_read_b64_tr_b16 v[166:167], v244 offset:38912
    v_mfma_f32_16x16x32_bf16 v[56:59], v[208:211], v[112:115], v[56:59]
    ds_read_b64_tr_b16 v[168:169], v245 offset:32768
    ds_read_b64_tr_b16 v[170:171], v245 offset:34816
    v_mfma_f32_16x16x32_bf16 v[56:59], v[212:215], v[116:119], v[56:59]
    ds_read_b64_tr_b16 v[172:173], v245 offset:36864
    ds_read_b64_tr_b16 v[174:175], v245 offset:38912
    v_mfma_f32_16x16x32_bf16 v[60:63], v[216:219], v[112:115], v[60:63]
    buffer_load_dwordx4 v[112:115], v248, s[52:55], s17 offen offset:0 sc1
    v_mfma_f32_16x16x32_bf16 v[60:63], v[220:223], v[116:119], v[60:63]
    buffer_load_dwordx4 v[116:119], v248, s[52:55], s17 offen offset:1024 sc1
    s_waitcnt vmcnt(10)
    v_mfma_f32_16x16x32_bf16 v[64:67], v[192:195], v[120:123], v[64:67]
    ds_read_b64_tr_b16 v[176:177], v246 offset:32768
    ds_read_b64_tr_b16 v[178:179], v246 offset:34816
    v_mfma_f32_16x16x32_bf16 v[64:67], v[196:199], v[124:127], v[64:67]
    ds_read_b64_tr_b16 v[180:181], v246 offset:36864
    ds_read_b64_tr_b16 v[182:183], v246 offset:38912
    v_mfma_f32_16x16x32_bf16 v[68:71], v[200:203], v[120:123], v[68:71]
    ds_read_b64_tr_b16 v[184:185], v247 offset:32768
    v_mfma_f32_16x16x32_bf16 v[68:71], v[204:207], v[124:127], v[68:71]
    ds_read_b64_tr_b16 v[186:187], v247 offset:34816
    v_mfma_f32_16x16x32_bf16 v[72:75], v[208:211], v[120:123], v[72:75]
    ds_read_b64_tr_b16 v[188:189], v247 offset:36864
    v_mfma_f32_16x16x32_bf16 v[72:75], v[212:215], v[124:127], v[72:75]
    ds_read_b64_tr_b16 v[190:191], v247 offset:38912
    v_mfma_f32_16x16x32_bf16 v[76:79], v[216:219], v[120:123], v[76:79]
    buffer_load_dwordx4 v[120:123], v248, s[52:55], s17 offen offset:2048 sc1
    v_mfma_f32_16x16x32_bf16 v[76:79], v[220:223], v[124:127], v[76:79]
    buffer_load_dwordx4 v[124:127], v248, s[52:55], s17 offen offset:3072 sc1
    s_waitcnt vmcnt(10) lgkmcnt(15)
    v_mfma_f32_16x16x32_bf16 v[16:19], v[128:131], v[80:83], v[16:19]
    ds_read_b64_tr_b16 v[192:193], v252 offset:32768
    v_mfma_f32_16x16x32_bf16 v[16:19], v[132:135], v[84:87], v[16:19]
    ds_read_b64_tr_b16 v[194:195], v252 offset:34816
    v_mfma_f32_16x16x32_bf16 v[20:23], v[136:139], v[80:83], v[20:23]
    ds_read_b64_tr_b16 v[196:197], v252 offset:36864
    v_mfma_f32_16x16x32_bf16 v[20:23], v[140:143], v[84:87], v[20:23]
    ds_read_b64_tr_b16 v[198:199], v252 offset:38912
    v_mfma_f32_16x16x32_bf16 v[24:27], v[144:147], v[80:83], v[24:27]
    ds_read_b64_tr_b16 v[200:201], v253 offset:32768
    v_mfma_f32_16x16x32_bf16 v[24:27], v[148:151], v[84:87], v[24:27]
    ds_read_b64_tr_b16 v[202:203], v253 offset:34816
    v_mfma_f32_16x16x32_bf16 v[28:31], v[152:155], v[80:83], v[28:31]
    buffer_load_dwordx4 v[80:83], v249, s[52:55], s17 offen offset:0 sc1
    v_mfma_f32_16x16x32_bf16 v[28:31], v[156:159], v[84:87], v[28:31]
    buffer_load_dwordx4 v[84:87], v249, s[52:55], s17 offen offset:1024 sc1
    s_waitcnt vmcnt(10)
    v_mfma_f32_16x16x32_bf16 v[32:35], v[128:131], v[88:91], v[32:35]
    ds_read_b64_tr_b16 v[204:205], v253 offset:36864
    v_mfma_f32_16x16x32_bf16 v[32:35], v[132:135], v[92:95], v[32:35]
    ds_read_b64_tr_b16 v[206:207], v253 offset:38912
    v_mfma_f32_16x16x32_bf16 v[36:39], v[136:139], v[88:91], v[36:39]
    ds_read_b64_tr_b16 v[208:209], v254 offset:32768
    v_mfma_f32_16x16x32_bf16 v[36:39], v[140:143], v[92:95], v[36:39]
    ds_read_b64_tr_b16 v[210:211], v254 offset:34816
    v_mfma_f32_16x16x32_bf16 v[40:43], v[144:147], v[88:91], v[40:43]
    ds_read_b64_tr_b16 v[212:213], v254 offset:36864
    v_mfma_f32_16x16x32_bf16 v[40:43], v[148:151], v[92:95], v[40:43]
    ds_read_b64_tr_b16 v[214:215], v254 offset:38912
    v_mfma_f32_16x16x32_bf16 v[44:47], v[152:155], v[88:91], v[44:47]
    buffer_load_dwordx4 v[88:91], v249, s[52:55], s17 offen offset:2048 sc1
    v_mfma_f32_16x16x32_bf16 v[44:47], v[156:159], v[92:95], v[44:47]
    buffer_load_dwordx4 v[92:95], v249, s[52:55], s17 offen offset:3072 sc1
    s_waitcnt vmcnt(10)
    v_mfma_f32_16x16x32_bf16 v[48:51], v[128:131], v[96:99], v[48:51]
    ds_read_b64_tr_b16 v[216:217], v255 offset:32768
    v_mfma_f32_16x16x32_bf16 v[48:51], v[132:135], v[100:103], v[48:51]
    ds_read_b64_tr_b16 v[218:219], v255 offset:34816
    v_mfma_f32_16x16x32_bf16 v[52:55], v[136:139], v[96:99], v[52:55]
    ds_read_b64_tr_b16 v[220:221], v255 offset:36864
    v_mfma_f32_16x16x32_bf16 v[52:55], v[140:143], v[100:103], v[52:55]
    ds_read_b64_tr_b16 v[222:223], v255 offset:38912
    v_mfma_f32_16x16x32_bf16 v[56:59], v[144:147], v[96:99], v[56:59]
    v_mfma_f32_16x16x32_bf16 v[56:59], v[148:151], v[100:103], v[56:59]
    v_mfma_f32_16x16x32_bf16 v[60:63], v[152:155], v[96:99], v[60:63]
    buffer_load_dwordx4 v[96:99], v250, s[52:55], s17 offen offset:0 sc1
    v_mfma_f32_16x16x32_bf16 v[60:63], v[156:159], v[100:103], v[60:63]
    buffer_load_dwordx4 v[100:103], v250, s[52:55], s17 offen offset:1024 sc1
    s_waitcnt vmcnt(10)
    v_mfma_f32_16x16x32_bf16 v[64:67], v[128:131], v[104:107], v[64:67]
    s_add_u32 s71, s3, 1
    s_and_b32 s71, s71, 3
    v_mfma_f32_16x16x32_bf16 v[64:67], v[132:135], v[108:111], v[64:67]
    s_lshl_b32 s71, s71, 12
    v_add_u32 v2, s71, v225
    v_mfma_f32_16x16x32_bf16 v[68:71], v[136:139], v[104:107], v[68:71]
    s_add_u32 s71, s3, 2
    s_and_b32 s71, s71, 3
    v_mfma_f32_16x16x32_bf16 v[68:71], v[140:143], v[108:111], v[68:71]
    s_lshl_b32 s71, s71, 12
    v_add_u32 v3, s71, v225
    v_mfma_f32_16x16x32_bf16 v[72:75], v[144:147], v[104:107], v[72:75]
    s_add_u32 s71, s3, 3
    s_and_b32 s71, s71, 3
    v_mfma_f32_16x16x32_bf16 v[72:75], v[148:151], v[108:111], v[72:75]
    s_lshl_b32 s71, s71, 12
    v_add_u32 v4, s71, v225
    v_mfma_f32_16x16x32_bf16 v[76:79], v[152:155], v[104:107], v[76:79]
    buffer_load_dwordx4 v[104:107], v250, s[52:55], s17 offen offset:2048 sc1
    v_mfma_f32_16x16x32_bf16 v[76:79], v[156:159], v[108:111], v[76:79]
    buffer_load_dwordx4 v[108:111], v250, s[52:55], s17 offen offset:3072 sc1
    s_waitcnt vmcnt(10) lgkmcnt(15)
    v_mfma_f32_16x16x32_bf16 v[16:19], v[160:163], v[112:115], v[16:19]
    v_add_u32 v4, 147456, v4
    v_mfma_f32_16x16x32_bf16 v[16:19], v[164:167], v[116:119], v[16:19]
    s_lshl_b32 s71, s3, 12
    v_mfma_f32_16x16x32_bf16 v[20:23], v[168:171], v[112:115], v[20:23]
    v_add_u32_e64 v5, s71, v225
    v_mfma_f32_16x16x32_bf16 v[20:23], v[172:175], v[116:119], v[20:23]
    v_add_u32 v6, 147456, v5
    v_mfma_f32_16x16x32_bf16 v[24:27], v[176:179], v[112:115], v[24:27]
    v_mfma_f32_16x16x32_bf16 v[24:27], v[180:183], v[116:119], v[24:27]
    v_mfma_f32_16x16x32_bf16 v[28:31], v[184:187], v[112:115], v[28:31]
    buffer_load_dwordx4 v[112:115], v251, s[52:55], s17 offen offset:0 sc1
    v_mfma_f32_16x16x32_bf16 v[28:31], v[188:191], v[116:119], v[28:31]
    buffer_load_dwordx4 v[116:119], v251, s[52:55], s17 offen offset:1024 sc1
    s_waitcnt vmcnt(10) lgkmcnt(0)
    v_mfma_f32_16x16x32_bf16 v[16:19], v[192:195], v[120:123], v[16:19]
    v_mfma_f32_16x16x32_bf16 v[16:19], v[196:199], v[124:127], v[16:19]
    v_mfma_f32_16x16x32_bf16 v[20:23], v[200:203], v[120:123], v[20:23]
    v_mfma_f32_16x16x32_bf16 v[20:23], v[204:207], v[124:127], v[20:23]
    v_mfma_f32_16x16x32_bf16 v[24:27], v[208:211], v[120:123], v[24:27]
    v_mfma_f32_16x16x32_bf16 v[24:27], v[212:215], v[124:127], v[24:27]
    v_mfma_f32_16x16x32_bf16 v[28:31], v[216:219], v[120:123], v[28:31]
    buffer_load_dwordx4 v[120:123], v251, s[52:55], s17 offen offset:2048 sc1
    v_mfma_f32_16x16x32_bf16 v[28:31], v[220:223], v[124:127], v[28:31]
    buffer_load_dwordx4 v[124:127], v251, s[52:55], s17 offen offset:3072 sc1
    s_waitcnt vmcnt(10)
    v_mfma_f32_16x16x32_bf16 v[32:35], v[160:163], v[80:83], v[32:35]
    s_nop 0
    v_mfma_f32_16x16x32_bf16 v[32:35], v[164:167], v[84:87], v[32:35]
    s_nop 0
    v_mfma_f32_16x16x32_bf16 v[36:39], v[168:171], v[80:83], v[36:39]
    ds_write_b128 v2, v[16:19] offset:0
    v_mfma_f32_16x16x32_bf16 v[36:39], v[172:175], v[84:87], v[36:39]
    ds_write_b128 v2, v[20:23] offset:1024
    v_mfma_f32_16x16x32_bf16 v[40:43], v[176:179], v[80:83], v[40:43]
    v_mfma_f32_16x16x32_bf16 v[40:43], v[180:183], v[84:87], v[40:43]
    v_mfma_f32_16x16x32_bf16 v[44:47], v[184:187], v[80:83], v[44:47]
    v_mfma_f32_16x16x32_bf16 v[44:47], v[188:191], v[84:87], v[44:47]
    s_waitcnt vmcnt(8)
    v_mfma_f32_16x16x32_bf16 v[32:35], v[192:195], v[88:91], v[32:35]
    ds_write_b128 v2, v[24:27] offset:2048
    v_mfma_f32_16x16x32_bf16 v[32:35], v[196:199], v[92:95], v[32:35]
    ds_write_b128 v2, v[28:31] offset:3072
    v_mfma_f32_16x16x32_bf16 v[36:39], v[200:203], v[88:91], v[36:39]
    v_mfma_f32_16x16x32_bf16 v[36:39], v[204:207], v[92:95], v[36:39]
    v_mfma_f32_16x16x32_bf16 v[40:43], v[208:211], v[88:91], v[40:43]
    v_mfma_f32_16x16x32_bf16 v[40:43], v[212:215], v[92:95], v[40:43]
    v_mfma_f32_16x16x32_bf16 v[44:47], v[216:219], v[88:91], v[44:47]
    v_mfma_f32_16x16x32_bf16 v[44:47], v[220:223], v[92:95], v[44:47]
    s_waitcnt vmcnt(6)
    v_mfma_f32_16x16x32_bf16 v[48:51], v[160:163], v[96:99], v[48:51]
    s_nop 0
    v_mfma_f32_16x16x32_bf16 v[48:51], v[164:167], v[100:103], v[48:51]
    s_nop 0
    v_mfma_f32_16x16x32_bf16 v[52:55], v[168:171], v[96:99], v[52:55]
    ds_write_b128 v3, v[32:35] offset:16384
    v_mfma_f32_16x16x32_bf16 v[52:55], v[172:175], v[100:103], v[52:55]
    ds_write_b128 v3, v[36:39] offset:17408
    v_mfma_f32_16x16x32_bf16 v[56:59], v[176:179], v[96:99], v[56:59]
    v_mfma_f32_16x16x32_bf16 v[56:59], v[180:183], v[100:103], v[56:59]
    v_mfma_f32_16x16x32_bf16 v[60:63], v[184:187], v[96:99], v[60:63]
    v_mfma_f32_16x16x32_bf16 v[60:63], v[188:191], v[100:103], v[60:63]
    s_waitcnt vmcnt(4)
    v_mfma_f32_16x16x32_bf16 v[48:51], v[192:195], v[104:107], v[48:51]
    ds_write_b128 v3, v[40:43] offset:18432
    v_mfma_f32_16x16x32_bf16 v[48:51], v[196:199], v[108:111], v[48:51]
    ds_write_b128 v3, v[44:47] offset:19456
    v_mfma_f32_16x16x32_bf16 v[52:55], v[200:203], v[104:107], v[52:55]
    v_mfma_f32_16x16x32_bf16 v[52:55], v[204:207], v[108:111], v[52:55]
    v_mfma_f32_16x16x32_bf16 v[56:59], v[208:211], v[104:107], v[56:59]
    v_mfma_f32_16x16x32_bf16 v[56:59], v[212:215], v[108:111], v[56:59]
    v_mfma_f32_16x16x32_bf16 v[60:63], v[216:219], v[104:107], v[60:63]
    v_mfma_f32_16x16x32_bf16 v[60:63], v[220:223], v[108:111], v[60:63]
    s_waitcnt vmcnt(2)
    v_mfma_f32_16x16x32_bf16 v[64:67], v[160:163], v[112:115], v[64:67]
    s_nop 0
    v_mfma_f32_16x16x32_bf16 v[64:67], v[164:167], v[116:119], v[64:67]
    s_nop 0
    v_mfma_f32_16x16x32_bf16 v[68:71], v[168:171], v[112:115], v[68:71]
    ds_write_b128 v4, v[48:51] offset:0
    v_mfma_f32_16x16x32_bf16 v[68:71], v[172:175], v[116:119], v[68:71]
    ds_write_b128 v4, v[52:55] offset:1024
    v_mfma_f32_16x16x32_bf16 v[72:75], v[176:179], v[112:115], v[72:75]
    v_mfma_f32_16x16x32_bf16 v[72:75], v[180:183], v[116:119], v[72:75]
    v_mfma_f32_16x16x32_bf16 v[76:79], v[184:187], v[112:115], v[76:79]
    v_mfma_f32_16x16x32_bf16 v[76:79], v[188:191], v[116:119], v[76:79]
    s_waitcnt vmcnt(0)
    v_mfma_f32_16x16x32_bf16 v[64:67], v[192:195], v[120:123], v[64:67]
    ds_write_b128 v4, v[56:59] offset:2048
    v_mfma_f32_16x16x32_bf16 v[64:67], v[196:199], v[124:127], v[64:67]
    ds_write_b128 v4, v[60:63] offset:3072
    v_mfma_f32_16x16x32_bf16 v[68:71], v[200:203], v[120:123], v[68:71]
    v_mfma_f32_16x16x32_bf16 v[68:71], v[204:207], v[124:127], v[68:71]
    v_mfma_f32_16x16x32_bf16 v[72:75], v[208:211], v[120:123], v[72:75]
    v_mfma_f32_16x16x32_bf16 v[72:75], v[212:215], v[124:127], v[72:75]
    v_mfma_f32_16x16x32_bf16 v[76:79], v[216:219], v[120:123], v[76:79]
    v_mfma_f32_16x16x32_bf16 v[76:79], v[220:223], v[124:127], v[76:79]
    s_waitcnt lgkmcnt(0)
    s_barrier
    s_nop 0
    ds_read_b128 v[128:131], v5 offset:0
    ds_read_b128 v[132:135], v5 offset:16384
    ds_read_b128 v[136:139], v6 offset:0
    ds_read_b128 v[140:143], v5 offset:1024
    ds_read_b128 v[144:147], v5 offset:17408
    ds_read_b128 v[148:151], v6 offset:1024
    ds_read_b128 v[152:155], v5 offset:2048
    ds_read_b128 v[156:159], v5 offset:18432
    ds_read_b128 v[160:163], v6 offset:2048
    ds_read_b128 v[164:167], v5 offset:3072
    ds_read_b128 v[168:171], v5 offset:19456
    ds_read_b128 v[172:175], v6 offset:3072
    s_waitcnt lgkmcnt(9)
    s_nop 0
    v_pk_add_f32 v[64:65], v[64:65], v[128:129]
    v_pk_add_f32 v[132:133], v[132:133], v[136:137]
    v_pk_add_f32 v[66:67], v[66:67], v[130:131]
    v_pk_add_f32 v[134:135], v[134:135], v[138:139]
    v_pk_add_f32 v[64:65], v[64:65], v[132:133]
    v_pk_add_f32 v[66:67], v[66:67], v[134:135]
    v_cvt_pk_bf16_f32 v80, v64, v65
    v_cvt_pk_bf16_f32 v81, v66, v67
    s_waitcnt lgkmcnt(6)
    s_nop 0
    v_pk_add_f32 v[68:69], v[68:69], v[140:141]
    v_pk_add_f32 v[144:145], v[144:145], v[148:149]
    v_pk_add_f32 v[70:71], v[70:71], v[142:143]
    v_pk_add_f32 v[146:147], v[146:147], v[150:151]
    v_pk_add_f32 v[68:69], v[68:69], v[144:145]
    v_pk_add_f32 v[70:71], v[70:71], v[146:147]
    v_cvt_pk_bf16_f32 v82, v68, v69
    v_cvt_pk_bf16_f32 v83, v70, v71
    s_nop 0
    v_permlane16_swap_b32 v80, v82
    v_permlane16_swap_b32 v81, v83
    buffer_store_dwordx4 v[80:83], v1, s[56:59], s18 offen offset:0 nt
    s_waitcnt lgkmcnt(3)
    v_pk_add_f32 v[72:73], v[72:73], v[152:153]
    v_pk_add_f32 v[156:157], v[156:157], v[160:161]
    v_pk_add_f32 v[74:75], v[74:75], v[154:155]
    v_pk_add_f32 v[158:159], v[158:159], v[162:163]
    v_pk_add_f32 v[72:73], v[72:73], v[156:157]
    v_pk_add_f32 v[74:75], v[74:75], v[158:159]
    v_cvt_pk_bf16_f32 v84, v72, v73
    v_cvt_pk_bf16_f32 v85, v74, v75
    s_waitcnt lgkmcnt(0)
    s_nop 0
    v_pk_add_f32 v[76:77], v[76:77], v[164:165]
    v_pk_add_f32 v[168:169], v[168:169], v[172:173]
    v_pk_add_f32 v[78:79], v[78:79], v[166:167]
    v_pk_add_f32 v[170:171], v[170:171], v[174:175]
    v_pk_add_f32 v[76:77], v[76:77], v[168:169]
    v_pk_add_f32 v[78:79], v[78:79], v[170:171]
    v_cvt_pk_bf16_f32 v86, v76, v77
    v_cvt_pk_bf16_f32 v87, v78, v79
    s_nop 0
    v_permlane16_swap_b32 v84, v86
    v_permlane16_swap_b32 v85, v87
    buffer_store_dwordx4 v[84:87], v1, s[56:59], s18 offen offset:64 nt
    s_endpgm
L_xretry_11:
    s_sub_u32 s79, s79, 1
    s_cmp_eq_u32 s79, 0
    s_cbranch_scc1 L_xdone_12
    s_sleep 2
    buffer_load_dword v20, v12, s[52:55], s62 offen offset:0 sc1
    buffer_load_dword v21, v12, s[52:55], s62 offen offset:1024 sc1
    buffer_load_dword v22, v12, s[52:55], s62 offen offset:2048 sc1
    buffer_load_dword v23, v12, s[52:55], s62 offen offset:3072 sc1
    buffer_load_dword v24, v12, s[52:55], s75 offen offset:0 sc1
    buffer_load_dword v25, v12, s[52:55], s75 offen offset:1024 sc1
    buffer_load_dword v26, v12, s[52:55], s75 offen offset:2048 sc1
    buffer_load_dword v27, v12, s[52:55], s75 offen offset:3072 sc1
    buffer_load_dwordx4 v[28:31], v15, s[52:55], s63 offen sc1
    s_waitcnt vmcnt(0)
    s_branch L_xchk_10
L_landm_18:
    s_mov_b32 s79, 2000000
L_land_16:
    v_mov_b32 v2, s64
    ds_read_b128 v[4:7], v2 offset:16
    s_waitcnt lgkmcnt(0)
    v_and_b32 v4, v4, v5
    v_and_b32 v6, v6, v7
    v_and_b32 v4, v4, v6
    s_nop 0
    v_readfirstlane_b32 s75, v4
    s_nop 0
    s_cmp_eq_u32 s75, 0
    s_cbranch_scc0 L_landd_17
    s_sub_u32 s79, s79, 1
    s_cmp_eq_u32 s79, 0
    s_cbranch_scc1 L_landd_17
    s_sleep 1
    s_branch L_land_16
L_chkm_21:
    s_mov_b32 s79, 200000
L_chk_19:
    s_load_dwordx4 s[44:47], s[40:41], 0 glc
    s_waitcnt lgkmcnt(0)
    s_xor_b64 s[44:45], s[44:45], s[42:43]
    s_xor_b64 s[46:47], s[46:47], s[42:43]
    s_or_b64 s[44:45], s[44:45], s[46:47]
    s_cbranch_scc0 L_chkd_20
    s_sub_u32 s79, s79, 1
    s_cmp_eq_u32 s79, 0
    s_cbranch_scc1 L_chkd_20
    s_branch L_chk_19
L_pairm_24:
    s_sub_u32 s79, s79, 1
    s_cmp_eq_u32 s79, 0
    s_cbranch_scc1 L_paird_25
    s_branch L_pair_23
L_landm_28:
    s_mov_b32 s79, 2000000
L_land_26:
    v_mov_b32 v2, s64
    ds_read_b128 v[244:247], v2 offset:16
    s_waitcnt lgkmcnt(0)
    v_and_b32 v244, v244, v245
    v_and_b32 v246, v246, v247
    v_and_b32 v244, v244, v246
    s_nop 0
    v_readfirstlane_b32 s75, v244
    s_nop 0
    s_cmp_eq_u32 s75, 0
    s_cbranch_scc0 L_landd_27
    s_sub_u32 s79, s79, 1
    s_cmp_eq_u32 s79, 0
    s_cbranch_scc1 L_landd_27
    s_sleep 1
    s_branch L_land_26
L_gretry_30:
    s_waitcnt lgkmcnt(0)
    s_sub_u32 s79, s79, 1
    s_cmp_eq_u32 s79, 0
    s_cbranch_scc1 L_gdone_31
    s_sleep 1
    s_branch L_gather_29
L_chkm_34:
    s_mov_b32 s79, 200000
L_chk_32:
    s_load_dwordx4 s[44:47], s[40:41], 0 glc
    s_waitcnt lgkmcnt(0)
    s_xor_b64 s[44:45], s[44:45], s[42:43]
    s_xor_b64 s[46:47], s[46:47], s[42:43]
    s_or_b64 s[44:45], s[44:45], s[46:47]
    s_cbranch_scc0 L_chkd_33
    s_sub_u32 s79, s79, 1
    s_cmp_eq_u32 s79, 0
    s_cbranch_scc1 L_chkd_33
    s_branch L_chk_32
L_pairm_36:
    s_sub_u32 s79, s79, 1
    s_cmp_eq_u32 s79, 0
    s_cbranch_scc1 L_paird_37
    s_branch L_pair_35
L_chkm_40:
    s_mov_b32 s79, 200000
L_chk_38:
    s_load_dwordx4 s[60:63], s[40:41], 1024 glc
    s_waitcnt lgkmcnt(0)
    s_xor_b64 s[60:61], s[60:61], s[42:43]
    s_xor_b64 s[62:63], s[62:63], s[42:43]
    s_or_b64 s[60:61], s[60:61], s[62:63]
    s_cbranch_scc0 L_chkd_39
    s_sub_u32 s79, s79, 1
    s_cmp_eq_u32 s79, 0
    s_cbranch_scc1 L_chkd_39
    s_branch L_chk_38
L_chkm_43:
    s_mov_b32 s79, 200000
L_chk_41:
    s_load_dwordx4 s[44:47], s[40:41], 4096 glc
    s_waitcnt lgkmcnt(0)
    s_xor_b64 s[44:45], s[44:45], s[42:43]
    s_xor_b64 s[46:47], s[46:47], s[42:43]
    s_or_b64 s[44:45], s[44:45], s[46:47]
    s_cbranch_scc0 L_chkd_42
    s_sub_u32 s79, s79, 1
    s_cmp_eq_u32 s79, 0
    s_cbranch_scc1 L_chkd_42
    s_branch L_chk_41
L_chkm_46:
    s_mov_b32 s79, 200000
L_chk_44:
    s_load_dwordx4 s[60:63], s[40:41], 2048 glc
    s_waitcnt lgkmcnt(0)
    s_xor_b64 s[60:61], s[60:61], s[42:43]
    s_xor_b64 s[62:63], s[62:63], s[42:43]
    s_or_b64 s[60:61], s[60:61], s[62:63]
    s_cbranch_scc0 L_chkd_45
    s_sub_u32 s79, s79, 1
    s_cmp_eq_u32 s79, 0
    s_cbranch_scc1 L_chkd_45
    s_branch L_chk_44
L_chkm_49:
    s_mov_b32 s79, 200000
L_chk_47:
    s_load_dwordx4 s[44:47], s[40:41], 3072 glc
    s_waitcnt lgkmcnt(0)
    s_xor_b64 s[44:45], s[44:45], s[42:43]
    s_xor_b64 s[46:47], s[46:47], s[42:43]
    s_or_b64 s[44:45], s[44:45], s[46:47]
    s_cbranch_scc0 L_chkd_48
    s_sub_u32 s79, s79, 1
    s_cmp_eq_u32 s79, 0
    s_cbranch_scc1 L_chkd_48
    s_branch L_chk_47
L_epoch_50:
    s_mov_b64 exec, 1
    buffer_store_dwordx2 v[12:13], off, s[52:55], 0 sc1
    s_mov_b64 exec, -1
    s_branch L_epochd_51
L_end:
    s_endpgm
L_code_end:
.section .rodata,"a"
.p2align 6
.amdhsa_kernel parallel_sum__linear_attn_block__dense_activation_mish__prompt_kernel
  .amdhsa_next_free_vgpr 256
  .amdhsa_next_free_sgpr 102
  .amdhsa_accum_offset 256
  .amdhsa_group_segment_fixed_size 0
  .amdhsa_kernarg_size 80
  .amdhsa_user_sgpr_count 2
  .amdhsa_user_sgpr_kernarg_segment_ptr 1
  .amdhsa_system_sgpr_workgroup_id_x 1
  .amdhsa_float_denorm_mode_32 3
.end_amdhsa_kernel
```
